```python
import torch

def _softmax(x, axis=-1):
    return torch.softmax(x, dim=axis)
def _gelu(x):
    return torch.nn.functional.gelu(x, approximate="tanh")
def _silu(x):
    return torch.nn.functional.silu(x)
def _sigmoid(x):
    return torch.sigmoid(x)
def _layernorm(x, axis=-1, eps=1e-5):
    m = x.mean(dim=axis, keepdim=True)
    v = x.var(dim=axis, keepdim=True, unbiased=False)
    return (x - m) / torch.sqrt(v + eps)
def _scatter_add(tgt, idx, src, axis=0):
    return tgt.clone().index_add_(axis, idx, src)
def _segment_sum(src, seg, n):
    out = torch.zeros((n,) + src.shape[1:], dtype=src.dtype)
    return out.index_add_(0, seg, src)
def _pad(x, pw):
    flat = tuple(v for pair in reversed(pw) for v in pair)
    return torch.nn.functional.pad(x, flat)

kernel_name = 'recurrent_scan__gqa_block_cached__dense_activation_silu__decode'

def setup_inputs():

    _w = (lambda a: (lambda t: t.to(torch.bfloat16) if t.is_floating_point() else t)(torch.as_tensor(a)))
    def _A_setup():
        B, Sq, D = 2, 1, 512
        Hq, Hkv, Sk, Dh = 32, 8, 32768, 128
        assert Hq % Hkv == 0, (Hq, Hkv)
        return {
            "x": _w((lambda *s: torch.randn(*s, dtype=torch.bfloat16) * 0.4)(B, Sq, D)),
            "k_cache": _w((lambda *s: torch.randn(*s, dtype=torch.bfloat16) * 1.6)(B, Hkv, Sk, Dh)),
            "v_cache": _w((lambda *s: torch.randn(*s, dtype=torch.bfloat16) * 1.6)(B, Hkv, Sk, Dh)),
            "wq": _w((lambda *s: torch.randn(*s, dtype=torch.bfloat16) * 1.6)(D, Hq * Dh) * (D ** -0.5)),
            "wo": _w((lambda *s: torch.randn(*s, dtype=torch.bfloat16) * 1.6)(Hq * Dh, D) * ((Hq * Dh) ** -0.5)),
        }
    _A_in = _A_setup()

    def _B_setup():
        B, S, D, F = 2, 1, 512, 1792
        return {
            "x": _w((lambda *s: torch.randn(*s, dtype=torch.bfloat16) * 0.4)(B, S, D)),
            "w1": _w((lambda *s: torch.randn(*s, dtype=torch.bfloat16) * 1.6)(D, F) * (D ** -0.5)),
            "w2": _w((lambda *s: torch.randn(*s, dtype=torch.bfloat16) * 1.6)(F, D) * (F ** -0.5)),
        }
    _B_in = _B_setup()

    return {
        "A_x": _A_in["x"],
        "A_k_cache": _A_in["k_cache"],
        "A_v_cache": _A_in["v_cache"],
        "A_wq": _A_in["wq"],
        "A_wo": _A_in["wo"],
        "B_x": _B_in["x"],
        "B_w1": _B_in["w1"],
        "B_w2": _B_in["w2"],
    }

def reference(A_x, A_k_cache, A_v_cache, A_wq, A_wo, B_x, B_w1, B_w2):
    def _A_ref(x, k_cache, v_cache, wq, wo):
        B, Sq, D = x.shape
        Hq, Dh = 32, 128
        Hkv = k_cache.shape[1]
        rep = Hq // Hkv
        q = (lambda x, *d: x.permute(*d))((x @ wq).reshape(B, Sq, Hq, Dh), 0, 2, 1, 3)
        k = (lambda x, n, axis: torch.repeat_interleave(x, n, dim=axis))(k_cache, rep, axis=1)
        v = (lambda x, n, axis: torch.repeat_interleave(x, n, dim=axis))(v_cache, rep, axis=1)
        scores = torch.einsum("bhqd,bhkd->bhqk", q, k) * (Dh ** -0.5)
        p = _softmax(scores, axis=-1)
        o = torch.einsum("bhqk,bhkd->bhqd", p, v)
        return (lambda x, *d: x.permute(*d))(o, 0, 2, 1, 3).reshape(B, Sq, Hq * Dh) @ wo

    def _B_ref(x, w1, w2):
        h = torch.einsum("bsd,df->bsf", x, w1)
        h = _silu(h)
        out = torch.einsum("bsf,fd->bsd", h, w2)
        return out

    x = A_x
    xn = _layernorm(x, axis=-1)
    s = _A_ref(xn, A_k_cache, A_v_cache, A_wq, A_wo)
    g = _silu(_B_ref(xn, B_w1, B_w2))
    return x + s * g
```

```asm
; @launch grid=(256,1,1) block=(512,1,1) lds=155648
.amdgcn_target "amdgcn-amd-amdhsa--gfx950"
.text
.globl recurrent_scan__gqa_block_cached__dense_activation_silu__decode_kernel
.p2align 8
.type recurrent_scan__gqa_block_cached__dense_activation_silu__decode_kernel,@function
recurrent_scan__gqa_block_cached__dense_activation_silu__decode_kernel:
  s_cmp_ge_u32 s2, 256
  s_cbranch_scc1 L_end
  s_load_dwordx16 s[4:19], s[0:1], 0
  s_load_dwordx4 s[20:23], s[0:1], 64
  s_load_dwordx2 s[24:25], s[0:1], 80
  v_lshrrev_b32 v1, 6, v0
  v_and_b32 v0, 63, v0
  v_readfirstlane_b32 s3, v1
  s_lshr_b32 s56, s2, 4
  s_and_b32 s57, s2, 15
  s_lshr_b32 s58, s56, 3
  s_and_b32 s59, s56, 7
  s_cmp_ge_u32 s3, 4
  s_cbranch_scc1 L_helper
  v_lshrrev_b32 v1, 4, v0
  v_and_b32 v2, 15, v0
  v_lshlrev_b32 v3, 8, v1
  v_xor_b32 v4, v2, v1
  v_xor_b32 v5, 0, v4
  v_lshl_add_u32 v8, v5, 4, v3
  v_xor_b32 v5, 4, v4
  v_lshl_add_u32 v9, v5, 4, v3
  v_xor_b32 v5, 8, v4
  v_lshl_add_u32 v10, v5, 4, v3
  v_xor_b32 v5, 12, v4
  v_lshl_add_u32 v11, v5, 4, v3
  v_lshlrev_b32 v4, 1, v1
  v_xor_b32 v4, v2, v4
  v_xor_b32 v5, 0, v4
  v_lshl_add_u32 v12, v5, 4, v3
  v_xor_b32 v5, 8, v4
  v_lshl_add_u32 v13, v5, 4, v3
  s_lshl_b32 s68, s3, 15
  s_lshl_b32 s69, s56, 23
  s_lshl_b32 s67, s57, 2
  s_add_u32 s67, s67, s3
  s_lshl_b32 s67, s67, 13
  s_mul_i32 s98, s56, 524288
  s_add_u32 s67, s67, s98
  s_waitcnt lgkmcnt(0)
  s_load_dword s27, s[24:25], 0
  s_mov_b32 s28, s6
  s_and_b32 s29, s7, 0xffff
  s_mov_b32 s30, 0x8000000
  s_mov_b32 s31, 0x20000
  s_mov_b32 s32, s8
  s_and_b32 s33, s9, 0xffff
  s_mov_b32 s34, 0x8000000
  s_mov_b32 s35, 0x20000
  s_and_b32 s71, s67, 0x7fffff
  s_add_u32 s71, s71, s69
  s_add_u32 m0, s68, 0
  s_mov_b32 s60, s71
  buffer_load_dwordx4 v8, s[28:31], s60 offen offset:0 nt lds
  buffer_load_dwordx4 v9, s[28:31], s60 offen offset:1024 nt lds
  buffer_load_dwordx4 v10, s[28:31], s60 offen offset:2048 nt lds
  buffer_load_dwordx4 v11, s[28:31], s60 offen offset:3072 nt lds
  s_add_u32 m0, s68, 4096
  s_add_u32 s60, s71, 4096
  buffer_load_dwordx4 v8, s[28:31], s60 offen offset:0 nt lds
  buffer_load_dwordx4 v9, s[28:31], s60 offen offset:1024 nt lds
  buffer_load_dwordx4 v10, s[28:31], s60 offen offset:2048 nt lds
  buffer_load_dwordx4 v11, s[28:31], s60 offen offset:3072 nt lds
  s_add_u32 m0, s68, 8192
  s_mov_b32 s60, s71
  buffer_load_dwordx4 v12, s[32:35], s60 offen offset:0 nt lds
  buffer_load_dwordx4 v13, s[32:35], s60 offen offset:1024 nt lds
  buffer_load_dwordx4 v12, s[32:35], s60 offen offset:2048 nt lds
  buffer_load_dwordx4 v13, s[32:35], s60 offen offset:3072 nt lds
  s_add_u32 m0, s68, 12288
  s_add_u32 s60, s71, 4096
  buffer_load_dwordx4 v12, s[32:35], s60 offen offset:0 nt lds
  buffer_load_dwordx4 v13, s[32:35], s60 offen offset:1024 nt lds
  buffer_load_dwordx4 v12, s[32:35], s60 offen offset:2048 nt lds
  buffer_load_dwordx4 v13, s[32:35], s60 offen offset:3072 nt lds
  s_add_u32 s67, s67, 524288
  s_and_b32 s71, s67, 0x7fffff
  s_add_u32 s71, s71, s69
  s_barrier
  s_waitcnt vmcnt(8)
  s_add_u32 m0, s68, 16384
  s_mov_b32 s60, s71
  buffer_load_dwordx4 v8, s[28:31], s60 offen offset:0 nt lds
  buffer_load_dwordx4 v9, s[28:31], s60 offen offset:1024 nt lds
  buffer_load_dwordx4 v10, s[28:31], s60 offen offset:2048 nt lds
  buffer_load_dwordx4 v11, s[28:31], s60 offen offset:3072 nt lds
  s_add_u32 m0, s68, 20480
  s_add_u32 s60, s71, 4096
  buffer_load_dwordx4 v8, s[28:31], s60 offen offset:0 nt lds
  buffer_load_dwordx4 v9, s[28:31], s60 offen offset:1024 nt lds
  buffer_load_dwordx4 v10, s[28:31], s60 offen offset:2048 nt lds
  buffer_load_dwordx4 v11, s[28:31], s60 offen offset:3072 nt lds
  s_waitcnt vmcnt(8)
  s_add_u32 m0, s68, 24576
  s_mov_b32 s60, s71
  buffer_load_dwordx4 v12, s[32:35], s60 offen offset:0 nt lds
  buffer_load_dwordx4 v13, s[32:35], s60 offen offset:1024 nt lds
  buffer_load_dwordx4 v12, s[32:35], s60 offen offset:2048 nt lds
  buffer_load_dwordx4 v13, s[32:35], s60 offen offset:3072 nt lds
  s_add_u32 m0, s68, 28672
  s_add_u32 s60, s71, 4096
  buffer_load_dwordx4 v12, s[32:35], s60 offen offset:0 nt lds
  buffer_load_dwordx4 v13, s[32:35], s60 offen offset:1024 nt lds
  buffer_load_dwordx4 v12, s[32:35], s60 offen offset:2048 nt lds
  buffer_load_dwordx4 v13, s[32:35], s60 offen offset:3072 nt lds
  s_add_u32 s67, s67, 524288
  v_and_b32 v1, 15, v0
  v_lshrrev_b32 v2, 4, v0
  v_xor_b32 v3, v2, v1
  v_lshlrev_b32 v4, 8, v1
  v_add_u32 v4, s68, v4
  v_xor_b32 v5, 0, v3
  v_lshl_add_u32 v14, v5, 4, v4
  v_xor_b32 v5, 4, v3
  v_lshl_add_u32 v15, v5, 4, v4
  v_xor_b32 v5, 8, v3
  v_lshl_add_u32 v16, v5, 4, v4
  v_xor_b32 v5, 12, v3
  v_lshl_add_u32 v17, v5, 4, v4
  v_lshrrev_b32 v1, 2, v0
  v_and_b32 v2, 7, v1
  v_and_b32 v3, 3, v0
  v_lshlrev_b32 v4, 8, v1
  v_lshl_add_u32 v4, v3, 3, v4
  v_add_u32 v4, s68, v4
  v_add_u32 v4, 8192, v4
  v_xor_b32 v5, 0, v2
  v_lshl_add_u32 v18, v5, 5, v4
  v_xor_b32 v5, 1, v2
  v_lshl_add_u32 v19, v5, 5, v4
  v_xor_b32 v5, 2, v2
  v_lshl_add_u32 v20, v5, 5, v4
  v_xor_b32 v5, 3, v2
  v_lshl_add_u32 v21, v5, 5, v4
  v_xor_b32 v5, 4, v2
  v_lshl_add_u32 v22, v5, 5, v4
  v_xor_b32 v5, 5, v2
  v_lshl_add_u32 v23, v5, 5, v4
  v_xor_b32 v5, 6, v2
  v_lshl_add_u32 v24, v5, 5, v4
  v_xor_b32 v5, 7, v2
  v_lshl_add_u32 v25, v5, 5, v4
  v_mov_b32 v44, 0
  v_mov_b32 v45, 0
  v_mov_b32 v46, 0
  v_mov_b32 v47, 0
  v_mov_b32 v48, 0
  v_mov_b32 v49, 0
  v_mov_b32 v50, 0
  v_mov_b32 v51, 0
  v_mov_b32 v52, 0
  v_mov_b32 v53, 0
  v_mov_b32 v54, 0
  v_mov_b32 v55, 0
  v_mov_b32 v56, 0
  v_mov_b32 v57, 0
  v_mov_b32 v58, 0
  v_mov_b32 v59, 0
  v_mov_b32 v60, 0
  v_mov_b32 v61, 0
  v_mov_b32 v62, 0
  v_mov_b32 v63, 0
  v_mov_b32 v64, 0
  v_mov_b32 v65, 0
  v_mov_b32 v66, 0
  v_mov_b32 v67, 0
  v_mov_b32 v68, 0
  v_mov_b32 v69, 0
  v_mov_b32 v70, 0
  v_mov_b32 v71, 0
  v_mov_b32 v72, 0
  v_mov_b32 v73, 0
  v_mov_b32 v74, 0
  v_mov_b32 v75, 0
  v_mov_b32 v28, 0
  v_mov_b32 v29, 0
  v_mov_b32 v30, 0
  v_mov_b32 v31, 0
  v_mov_b32 v32, 0
  v_mov_b32 v33, 0
  v_mov_b32 v34, 0
  v_mov_b32 v35, 0
  v_mov_b32 v36, 0
  v_mov_b32 v37, 0
  v_mov_b32 v38, 0
  v_mov_b32 v39, 0
  v_mov_b32 v40, 0
  v_mov_b32 v41, 0
  v_mov_b32 v42, 0
  v_mov_b32 v43, 0
  v_mov_b32 v224, 0xff800000
  v_mov_b32 v236, 0
  v_mov_b32 v237, 0
  v_mov_b32 v238, 0
  v_mov_b32 v239, 0
  v_mov_b32 v225, 0
  s_mov_b32 s36, s24
  s_and_b32 s37, s25, 0xffff
  s_mov_b32 s38, 0x800000
  s_mov_b32 s39, 0x20000
  s_mov_b32 s44, s4
  s_and_b32 s45, s5, 0xffff
  s_mov_b32 s46, 0x800
  s_mov_b32 s47, 0x20000
  s_mov_b32 s52, s12
  s_and_b32 s53, s13, 0xffff
  s_mov_b32 s54, 0x400000
  s_mov_b32 s55, 0x20000
  s_mov_b32 s48, s20
  s_and_b32 s49, s21, 0xffff
  s_mov_b32 s50, 0x800
  s_mov_b32 s51, 0x20000
  s_waitcnt vmcnt(24)
  ds_read_b128 v[76:79], v14 offset:0
  ds_read_b128 v[80:83], v15 offset:0
  ds_read_b128 v[84:87], v16 offset:0
  ds_read_b128 v[88:91], v17 offset:0
  ds_read_b128 v[92:95], v14 offset:4096
  ds_read_b128 v[96:99], v15 offset:4096
  ds_read_b128 v[100:103], v16 offset:4096
  ds_read_b128 v[104:107], v17 offset:4096
  s_waitcnt lgkmcnt(0)
  s_and_b32 s71, s67, 0x7fffff
  s_add_u32 s71, s71, s69
  s_waitcnt vmcnt(8)
  s_add_u32 m0, s68, 0
  s_mov_b32 s60, s71
  buffer_load_dwordx4 v8, s[28:31], s60 offen offset:0 nt lds
  buffer_load_dwordx4 v9, s[28:31], s60 offen offset:1024 nt lds
  buffer_load_dwordx4 v10, s[28:31], s60 offen offset:2048 nt lds
  buffer_load_dwordx4 v11, s[28:31], s60 offen offset:3072 nt lds
  s_add_u32 m0, s68, 4096
  s_add_u32 s60, s71, 4096
  buffer_load_dwordx4 v8, s[28:31], s60 offen offset:0 nt lds
  buffer_load_dwordx4 v9, s[28:31], s60 offen offset:1024 nt lds
  buffer_load_dwordx4 v10, s[28:31], s60 offen offset:2048 nt lds
  buffer_load_dwordx4 v11, s[28:31], s60 offen offset:3072 nt lds
  s_waitcnt vmcnt(24)
  ds_read_b64_tr_b16 v[108:109], v18 offset:0
  ds_read_b64_tr_b16 v[110:111], v18 offset:4096
  ds_read_b64_tr_b16 v[112:113], v19 offset:0
  ds_read_b64_tr_b16 v[114:115], v19 offset:4096
  ds_read_b64_tr_b16 v[116:117], v20 offset:0
  ds_read_b64_tr_b16 v[118:119], v20 offset:4096
  ds_read_b64_tr_b16 v[120:121], v21 offset:0
  ds_read_b64_tr_b16 v[122:123], v21 offset:4096
  ds_read_b64_tr_b16 v[124:125], v22 offset:0
  ds_read_b64_tr_b16 v[126:127], v22 offset:4096
  ds_read_b64_tr_b16 v[128:129], v23 offset:0
  ds_read_b64_tr_b16 v[130:131], v23 offset:4096
  ds_read_b64_tr_b16 v[132:133], v24 offset:0
  ds_read_b64_tr_b16 v[134:135], v24 offset:4096
  ds_read_b64_tr_b16 v[136:137], v25 offset:0
  ds_read_b64_tr_b16 v[138:139], v25 offset:4096
  s_waitcnt lgkmcnt(0)
  s_waitcnt vmcnt(8)
  s_add_u32 m0, s68, 8192
  s_mov_b32 s60, s71
  buffer_load_dwordx4 v12, s[32:35], s60 offen offset:0 nt lds
  buffer_load_dwordx4 v13, s[32:35], s60 offen offset:1024 nt lds
  buffer_load_dwordx4 v12, s[32:35], s60 offen offset:2048 nt lds
  buffer_load_dwordx4 v13, s[32:35], s60 offen offset:3072 nt lds
  s_add_u32 m0, s68, 12288
  s_add_u32 s60, s71, 4096
  buffer_load_dwordx4 v12, s[32:35], s60 offen offset:0 nt lds
  buffer_load_dwordx4 v13, s[32:35], s60 offen offset:1024 nt lds
  buffer_load_dwordx4 v12, s[32:35], s60 offen offset:2048 nt lds
  buffer_load_dwordx4 v13, s[32:35], s60 offen offset:3072 nt lds
  s_add_u32 s67, s67, 524288
  s_waitcnt vmcnt(24)
  ds_read_b128 v[140:143], v14 offset:16384
  ds_read_b128 v[144:147], v15 offset:16384
  ds_read_b128 v[148:151], v16 offset:16384
  ds_read_b128 v[152:155], v17 offset:16384
  ds_read_b128 v[156:159], v14 offset:20480
  ds_read_b128 v[160:163], v15 offset:20480
  ds_read_b128 v[164:167], v16 offset:20480
  ds_read_b128 v[168:171], v17 offset:20480
  s_waitcnt lgkmcnt(0)
  s_and_b32 s71, s67, 0x7fffff
  s_add_u32 s71, s71, s69
  s_waitcnt vmcnt(8)
  s_add_u32 m0, s68, 16384
  s_mov_b32 s60, s71
  buffer_load_dwordx4 v8, s[28:31], s60 offen offset:0 nt lds
  buffer_load_dwordx4 v9, s[28:31], s60 offen offset:1024 nt lds
  buffer_load_dwordx4 v10, s[28:31], s60 offen offset:2048 nt lds
  buffer_load_dwordx4 v11, s[28:31], s60 offen offset:3072 nt lds
  s_add_u32 m0, s68, 20480
  s_add_u32 s60, s71, 4096
  buffer_load_dwordx4 v8, s[28:31], s60 offen offset:0 nt lds
  buffer_load_dwordx4 v9, s[28:31], s60 offen offset:1024 nt lds
  buffer_load_dwordx4 v10, s[28:31], s60 offen offset:2048 nt lds
  buffer_load_dwordx4 v11, s[28:31], s60 offen offset:3072 nt lds
  s_waitcnt vmcnt(24)
  ds_read_b64_tr_b16 v[172:173], v18 offset:16384
  ds_read_b64_tr_b16 v[174:175], v18 offset:20480
  ds_read_b64_tr_b16 v[176:177], v19 offset:16384
  ds_read_b64_tr_b16 v[178:179], v19 offset:20480
  ds_read_b64_tr_b16 v[180:181], v20 offset:16384
  ds_read_b64_tr_b16 v[182:183], v20 offset:20480
  ds_read_b64_tr_b16 v[184:185], v21 offset:16384
  ds_read_b64_tr_b16 v[186:187], v21 offset:20480
  ds_read_b64_tr_b16 v[188:189], v22 offset:16384
  ds_read_b64_tr_b16 v[190:191], v22 offset:20480
  ds_read_b64_tr_b16 v[192:193], v23 offset:16384
  ds_read_b64_tr_b16 v[194:195], v23 offset:20480
  ds_read_b64_tr_b16 v[196:197], v24 offset:16384
  ds_read_b64_tr_b16 v[198:199], v24 offset:20480
  ds_read_b64_tr_b16 v[200:201], v25 offset:16384
  ds_read_b64_tr_b16 v[202:203], v25 offset:20480
  s_waitcnt lgkmcnt(0)
  s_waitcnt vmcnt(8)
  s_add_u32 m0, s68, 24576
  s_mov_b32 s60, s71
  buffer_load_dwordx4 v12, s[32:35], s60 offen offset:0 nt lds
  buffer_load_dwordx4 v13, s[32:35], s60 offen offset:1024 nt lds
  buffer_load_dwordx4 v12, s[32:35], s60 offen offset:2048 nt lds
  buffer_load_dwordx4 v13, s[32:35], s60 offen offset:3072 nt lds
  s_add_u32 m0, s68, 28672
  s_add_u32 s60, s71, 4096
  buffer_load_dwordx4 v12, s[32:35], s60 offen offset:0 nt lds
  buffer_load_dwordx4 v13, s[32:35], s60 offen offset:1024 nt lds
  buffer_load_dwordx4 v12, s[32:35], s60 offen offset:2048 nt lds
  buffer_load_dwordx4 v13, s[32:35], s60 offen offset:3072 nt lds
  s_add_u32 s67, s67, 524288
  s_waitcnt lgkmcnt(0)
  s_mul_i32 s26, s27, 1664525
  s_add_u32 s26, s26, 1013904223
  s_barrier
  v_and_b32 v1, 15, v0
  v_lshrrev_b32 v2, 4, v0
  v_lshlrev_b32 v1, 8, v1
  v_lshl_add_u32 v1, v2, 4, v1
  v_add_u32 v1, 151552, v1
  s_mov_b32 s74, 0x000f000f
  s_mov_b32 s75, 0x000f000f
  s_mov_b64 exec, s[74:75]
  ds_read_b128 v[28:31], v1 offset:0
  ds_read_b128 v[32:35], v1 offset:64
  ds_read_b128 v[36:39], v1 offset:128
  ds_read_b128 v[40:43], v1 offset:192
  s_mov_b64 exec, -1
  s_mov_b32 s96, 0x3fb8aa3b
  s_mov_b32 s97, 0x3db504f3
  s_waitcnt lgkmcnt(0)
  s_sub_u32 s99, s67, s98
  s_lshr_b32 s99, s99, 13
  s_sub_u32 s99, s99, 640
  s_add_u32 s95, s99, 640
  v_mov_b32 v233, s99
  v_mov_b32 v234, 1
  s_lshl_b32 s60, s56, 8
  s_add_u32 s60, s60, 2752512
  v_mov_b32 v235, s60
  s_mov_b32 s70, 0
  s_mov_b32 s73, 0
  v_mfma_f32_16x16x32_bf16 v[204:207], v[76:79], v[28:31], 0
  v_mfma_f32_16x16x32_bf16 v[208:211], v[92:95], v[28:31], 0
  v_mfma_f32_16x16x32_bf16 v[204:207], v[80:83], v[32:35], v[204:207]
  v_mfma_f32_16x16x32_bf16 v[208:211], v[96:99], v[32:35], v[208:211]
  v_mfma_f32_16x16x32_bf16 v[204:207], v[84:87], v[36:39], v[204:207]
  v_mfma_f32_16x16x32_bf16 v[208:211], v[100:103], v[36:39], v[208:211]
  v_mfma_f32_16x16x32_bf16 v[204:207], v[88:91], v[40:43], v[204:207]
  v_mfma_f32_16x16x32_bf16 v[208:211], v[104:107], v[40:43], v[208:211]
  s_nop 7
  v_cvt_pk_bf16_f32 v229, v204, v205
  v_cvt_pk_bf16_f32 v230, v206, v207
  v_cvt_pk_bf16_f32 v231, v208, v209
  v_cvt_pk_bf16_f32 v232, v210, v211
  v_lshlrev_b32 v212, 16, v229
  v_and_b32 v213, 0xffff0000, v229
  v_lshlrev_b32 v214, 16, v230
  v_and_b32 v215, 0xffff0000, v230
  v_lshlrev_b32 v216, 16, v231
  v_and_b32 v217, 0xffff0000, v231
  v_lshlrev_b32 v218, 16, v232
  v_and_b32 v219, 0xffff0000, v232
  v_mul_f32 v212, s97, v212
  v_mul_f32 v213, s97, v213
  v_mul_f32 v214, s97, v214
  v_mul_f32 v215, s97, v215
  v_mul_f32 v216, s97, v216
  v_mul_f32 v217, s97, v217
  v_mul_f32 v218, s97, v218
  v_mul_f32 v219, s97, v219
  v_cvt_pk_bf16_f32 v229, v212, v213
  v_cvt_pk_bf16_f32 v230, v214, v215
  v_cvt_pk_bf16_f32 v231, v216, v217
  v_cvt_pk_bf16_f32 v232, v218, v219
  v_lshlrev_b32 v212, 16, v229
  v_and_b32 v213, 0xffff0000, v229
  v_lshlrev_b32 v214, 16, v230
  v_and_b32 v215, 0xffff0000, v230
  v_lshlrev_b32 v216, 16, v231
  v_and_b32 v217, 0xffff0000, v231
  v_lshlrev_b32 v218, 16, v232
  v_and_b32 v219, 0xffff0000, v232
  v_max3_f32 v228, v212, v213, v214
  v_max3_f32 v228, v228, v215, v216
  v_max3_f32 v228, v228, v217, v218
  v_max3_f32 v228, v228, v219, v224
  v_mov_b32 v229, v228
  s_nop 1
  v_permlane16_swap_b32 v228, v229
  s_nop 0
  v_max_f32 v228, v228, v229
  v_mov_b32 v229, v228
  s_nop 1
  v_permlane32_swap_b32 v228, v229
  s_nop 0
  v_max_f32 v228, v228, v229
  v_sub_f32 v226, v224, v228
  v_mul_f32 v226, s96, v226
  v_exp_f32 v226, v226
  v_mov_b32 v224, v228
  v_mul_f32 v227, s96, v228
  v_fma_f32 v212, v212, s96, -v227
  v_fma_f32 v213, v213, s96, -v227
  v_fma_f32 v214, v214, s96, -v227
  v_fma_f32 v215, v215, s96, -v227
  v_fma_f32 v216, v216, s96, -v227
  v_fma_f32 v217, v217, s96, -v227
  v_fma_f32 v218, v218, s96, -v227
  v_fma_f32 v219, v219, s96, -v227
  v_exp_f32 v212, v212
  v_exp_f32 v213, v213
  v_exp_f32 v214, v214
  v_exp_f32 v215, v215
  v_exp_f32 v216, v216
  v_exp_f32 v217, v217
  v_exp_f32 v218, v218
  v_exp_f32 v219, v219
  v_mul_f32 v225, v225, v226
  v_pk_mul_f32 v[44:45], v[44:45], v[226:227] op_sel_hi:[1,0]
  v_pk_mul_f32 v[46:47], v[46:47], v[226:227] op_sel_hi:[1,0]
  v_pk_mul_f32 v[48:49], v[48:49], v[226:227] op_sel_hi:[1,0]
  v_pk_mul_f32 v[50:51], v[50:51], v[226:227] op_sel_hi:[1,0]
  v_pk_mul_f32 v[52:53], v[52:53], v[226:227] op_sel_hi:[1,0]
  v_pk_mul_f32 v[54:55], v[54:55], v[226:227] op_sel_hi:[1,0]
  v_pk_mul_f32 v[56:57], v[56:57], v[226:227] op_sel_hi:[1,0]
  v_pk_mul_f32 v[58:59], v[58:59], v[226:227] op_sel_hi:[1,0]
  v_pk_mul_f32 v[60:61], v[60:61], v[226:227] op_sel_hi:[1,0]
  v_pk_mul_f32 v[62:63], v[62:63], v[226:227] op_sel_hi:[1,0]
  v_pk_mul_f32 v[64:65], v[64:65], v[226:227] op_sel_hi:[1,0]
  v_pk_mul_f32 v[66:67], v[66:67], v[226:227] op_sel_hi:[1,0]
  v_pk_mul_f32 v[68:69], v[68:69], v[226:227] op_sel_hi:[1,0]
  v_pk_mul_f32 v[70:71], v[70:71], v[226:227] op_sel_hi:[1,0]
  v_pk_mul_f32 v[72:73], v[72:73], v[226:227] op_sel_hi:[1,0]
  v_pk_mul_f32 v[74:75], v[74:75], v[226:227] op_sel_hi:[1,0]
  v_cvt_pk_bf16_f32 v220, v212, v213
  v_cvt_pk_bf16_f32 v221, v214, v215
  v_cvt_pk_bf16_f32 v222, v216, v217
  v_cvt_pk_bf16_f32 v223, v218, v219
  v_add_f32 v229, v212, v213
  v_add_f32 v230, v214, v215
  v_add_f32 v231, v216, v217
  v_add_f32 v232, v218, v219
  v_add_f32 v229, v229, v230
  v_add_f32 v231, v231, v232
  v_add_f32 v229, v229, v231
  v_add_f32 v225, v225, v229
  v_mfma_f32_16x16x32_bf16 v[44:47], v[108:111], v[220:223], v[44:47]
  v_mfma_f32_16x16x32_bf16 v[48:51], v[112:115], v[220:223], v[48:51]
  v_mfma_f32_16x16x32_bf16 v[52:55], v[116:119], v[220:223], v[52:55]
  v_mfma_f32_16x16x32_bf16 v[56:59], v[120:123], v[220:223], v[56:59]
  v_mfma_f32_16x16x32_bf16 v[60:63], v[124:127], v[220:223], v[60:63]
  v_mfma_f32_16x16x32_bf16 v[64:67], v[128:131], v[220:223], v[64:67]
  v_mfma_f32_16x16x32_bf16 v[68:71], v[132:135], v[220:223], v[68:71]
  v_mfma_f32_16x16x32_bf16 v[72:75], v[136:139], v[220:223], v[72:75]
  s_waitcnt vmcnt(24)
  ds_read_b128 v[76:79], v14 offset:0
  ds_read_b128 v[80:83], v15 offset:0
  ds_read_b128 v[84:87], v16 offset:0
  ds_read_b128 v[88:91], v17 offset:0
  ds_read_b128 v[92:95], v14 offset:4096
  ds_read_b128 v[96:99], v15 offset:4096
  ds_read_b128 v[100:103], v16 offset:4096
  ds_read_b128 v[104:107], v17 offset:4096
  s_waitcnt lgkmcnt(0)
  v_readfirstlane_b32 s99, v233
  s_add_u32 s99, s99, 640
  s_cmp_ge_u32 s99, 1024
  s_cbranch_scc1 L_ldone
  s_lshl_b32 s67, s99, 13
  s_add_u32 s67, s67, s98
  s_and_b32 s71, s67, 0x7fffff
  s_add_u32 s71, s71, s69
  s_add_u32 m0, s68, 0
  s_mov_b32 s60, s71
  buffer_load_dwordx4 v8, s[28:31], s60 offen offset:0 nt lds
  buffer_load_dwordx4 v9, s[28:31], s60 offen offset:1024 nt lds
  buffer_load_dwordx4 v10, s[28:31], s60 offen offset:2048 nt lds
  buffer_load_dwordx4 v11, s[28:31], s60 offen offset:3072 nt lds
  s_add_u32 m0, s68, 4096
  s_add_u32 s60, s71, 4096
  buffer_load_dwordx4 v8, s[28:31], s60 offen offset:0 nt lds
  buffer_load_dwordx4 v9, s[28:31], s60 offen offset:1024 nt lds
  buffer_load_dwordx4 v10, s[28:31], s60 offen offset:2048 nt lds
  buffer_load_dwordx4 v11, s[28:31], s60 offen offset:3072 nt lds
  s_waitcnt vmcnt(24)
  ds_read_b64_tr_b16 v[108:109], v18 offset:0
  ds_read_b64_tr_b16 v[110:111], v18 offset:4096
  ds_read_b64_tr_b16 v[112:113], v19 offset:0
  ds_read_b64_tr_b16 v[114:115], v19 offset:4096
  ds_read_b64_tr_b16 v[116:117], v20 offset:0
  ds_read_b64_tr_b16 v[118:119], v20 offset:4096
  ds_read_b64_tr_b16 v[120:121], v21 offset:0
  ds_read_b64_tr_b16 v[122:123], v21 offset:4096
  ds_read_b64_tr_b16 v[124:125], v22 offset:0
  ds_read_b64_tr_b16 v[126:127], v22 offset:4096
  ds_read_b64_tr_b16 v[128:129], v23 offset:0
  ds_read_b64_tr_b16 v[130:131], v23 offset:4096
  ds_read_b64_tr_b16 v[132:133], v24 offset:0
  ds_read_b64_tr_b16 v[134:135], v24 offset:4096
  ds_read_b64_tr_b16 v[136:137], v25 offset:0
  ds_read_b64_tr_b16 v[138:139], v25 offset:4096
  s_waitcnt lgkmcnt(0)
  s_add_u32 m0, s68, 8192
  s_mov_b32 s60, s71
  buffer_load_dwordx4 v12, s[32:35], s60 offen offset:0 nt lds
  buffer_load_dwordx4 v13, s[32:35], s60 offen offset:1024 nt lds
  buffer_load_dwordx4 v12, s[32:35], s60 offen offset:2048 nt lds
  buffer_load_dwordx4 v13, s[32:35], s60 offen offset:3072 nt lds
  s_add_u32 m0, s68, 12288
  s_add_u32 s60, s71, 4096
  buffer_load_dwordx4 v12, s[32:35], s60 offen offset:0 nt lds
  buffer_load_dwordx4 v13, s[32:35], s60 offen offset:1024 nt lds
  buffer_load_dwordx4 v12, s[32:35], s60 offen offset:2048 nt lds
  buffer_load_dwordx4 v13, s[32:35], s60 offen offset:3072 nt lds
  v_mfma_f32_16x16x32_bf16 v[204:207], v[140:143], v[28:31], 0
  v_mfma_f32_16x16x32_bf16 v[208:211], v[156:159], v[28:31], 0
  v_mfma_f32_16x16x32_bf16 v[204:207], v[144:147], v[32:35], v[204:207]
  v_mfma_f32_16x16x32_bf16 v[208:211], v[160:163], v[32:35], v[208:211]
  v_mfma_f32_16x16x32_bf16 v[204:207], v[148:151], v[36:39], v[204:207]
  v_mfma_f32_16x16x32_bf16 v[208:211], v[164:167], v[36:39], v[208:211]
  v_mfma_f32_16x16x32_bf16 v[204:207], v[152:155], v[40:43], v[204:207]
  v_mfma_f32_16x16x32_bf16 v[208:211], v[168:171], v[40:43], v[208:211]
  s_nop 7
  v_cvt_pk_bf16_f32 v229, v204, v205
  v_cvt_pk_bf16_f32 v230, v206, v207
  v_cvt_pk_bf16_f32 v231, v208, v209
  v_cvt_pk_bf16_f32 v232, v210, v211
  v_lshlrev_b32 v212, 16, v229
  v_and_b32 v213, 0xffff0000, v229
  v_lshlrev_b32 v214, 16, v230
  v_and_b32 v215, 0xffff0000, v230
  v_lshlrev_b32 v216, 16, v231
  v_and_b32 v217, 0xffff0000, v231
  v_lshlrev_b32 v218, 16, v232
  v_and_b32 v219, 0xffff0000, v232
  v_mul_f32 v212, s97, v212
  v_mul_f32 v213, s97, v213
  v_mul_f32 v214, s97, v214
  v_mul_f32 v215, s97, v215
  v_mul_f32 v216, s97, v216
  v_mul_f32 v217, s97, v217
  v_mul_f32 v218, s97, v218
  v_mul_f32 v219, s97, v219
  v_cvt_pk_bf16_f32 v229, v212, v213
  v_cvt_pk_bf16_f32 v230, v214, v215
  v_cvt_pk_bf16_f32 v231, v216, v217
  v_cvt_pk_bf16_f32 v232, v218, v219
  v_lshlrev_b32 v212, 16, v229
  v_and_b32 v213, 0xffff0000, v229
  v_lshlrev_b32 v214, 16, v230
  v_and_b32 v215, 0xffff0000, v230
  v_lshlrev_b32 v216, 16, v231
  v_and_b32 v217, 0xffff0000, v231
  v_lshlrev_b32 v218, 16, v232
  v_and_b32 v219, 0xffff0000, v232
  v_max3_f32 v228, v212, v213, v214
  v_max3_f32 v228, v228, v215, v216
  v_max3_f32 v228, v228, v217, v218
  v_max3_f32 v228, v228, v219, v224
  v_mov_b32 v229, v228
  s_nop 1
  v_permlane16_swap_b32 v228, v229
  s_nop 0
  v_max_f32 v228, v228, v229
  v_mov_b32 v229, v228
  s_nop 1
  v_permlane32_swap_b32 v228, v229
  s_nop 0
  v_max_f32 v228, v228, v229
  v_sub_f32 v226, v224, v228
  v_mul_f32 v226, s96, v226
  v_exp_f32 v226, v226
  v_mov_b32 v224, v228
  v_mul_f32 v227, s96, v228
  v_fma_f32 v212, v212, s96, -v227
  v_fma_f32 v213, v213, s96, -v227
  v_fma_f32 v214, v214, s96, -v227
  v_fma_f32 v215, v215, s96, -v227
  v_fma_f32 v216, v216, s96, -v227
  v_fma_f32 v217, v217, s96, -v227
  v_fma_f32 v218, v218, s96, -v227
  v_fma_f32 v219, v219, s96, -v227
  v_exp_f32 v212, v212
  v_exp_f32 v213, v213
  v_exp_f32 v214, v214
  v_exp_f32 v215, v215
  v_exp_f32 v216, v216
  v_exp_f32 v217, v217
  v_exp_f32 v218, v218
  v_exp_f32 v219, v219
  v_mul_f32 v225, v225, v226
  v_pk_mul_f32 v[44:45], v[44:45], v[226:227] op_sel_hi:[1,0]
  v_pk_mul_f32 v[46:47], v[46:47], v[226:227] op_sel_hi:[1,0]
  v_pk_mul_f32 v[48:49], v[48:49], v[226:227] op_sel_hi:[1,0]
  v_pk_mul_f32 v[50:51], v[50:51], v[226:227] op_sel_hi:[1,0]
  v_pk_mul_f32 v[52:53], v[52:53], v[226:227] op_sel_hi:[1,0]
  v_pk_mul_f32 v[54:55], v[54:55], v[226:227] op_sel_hi:[1,0]
  v_pk_mul_f32 v[56:57], v[56:57], v[226:227] op_sel_hi:[1,0]
  v_pk_mul_f32 v[58:59], v[58:59], v[226:227] op_sel_hi:[1,0]
  v_pk_mul_f32 v[60:61], v[60:61], v[226:227] op_sel_hi:[1,0]
  v_pk_mul_f32 v[62:63], v[62:63], v[226:227] op_sel_hi:[1,0]
  v_pk_mul_f32 v[64:65], v[64:65], v[226:227] op_sel_hi:[1,0]
  v_pk_mul_f32 v[66:67], v[66:67], v[226:227] op_sel_hi:[1,0]
  v_pk_mul_f32 v[68:69], v[68:69], v[226:227] op_sel_hi:[1,0]
  v_pk_mul_f32 v[70:71], v[70:71], v[226:227] op_sel_hi:[1,0]
  v_pk_mul_f32 v[72:73], v[72:73], v[226:227] op_sel_hi:[1,0]
  v_pk_mul_f32 v[74:75], v[74:75], v[226:227] op_sel_hi:[1,0]
  v_cvt_pk_bf16_f32 v220, v212, v213
  v_cvt_pk_bf16_f32 v221, v214, v215
  v_cvt_pk_bf16_f32 v222, v216, v217
  v_cvt_pk_bf16_f32 v223, v218, v219
  v_add_f32 v229, v212, v213
  v_add_f32 v230, v214, v215
  v_add_f32 v231, v216, v217
  v_add_f32 v232, v218, v219
  v_add_f32 v229, v229, v230
  v_add_f32 v231, v231, v232
  v_add_f32 v229, v229, v231
  v_add_f32 v225, v225, v229
  v_mfma_f32_16x16x32_bf16 v[44:47], v[172:175], v[220:223], v[44:47]
  v_mfma_f32_16x16x32_bf16 v[48:51], v[176:179], v[220:223], v[48:51]
  v_mfma_f32_16x16x32_bf16 v[52:55], v[180:183], v[220:223], v[52:55]
  v_mfma_f32_16x16x32_bf16 v[56:59], v[184:187], v[220:223], v[56:59]
  v_mfma_f32_16x16x32_bf16 v[60:63], v[188:191], v[220:223], v[60:63]
  v_mfma_f32_16x16x32_bf16 v[64:67], v[192:195], v[220:223], v[64:67]
  v_mfma_f32_16x16x32_bf16 v[68:71], v[196:199], v[220:223], v[68:71]
  v_mfma_f32_16x16x32_bf16 v[72:75], v[200:203], v[220:223], v[72:75]
  s_add_u32 s95, s95, 64
  s_cmp_ge_u32 s95, 640
  s_cbranch_scc1 L_rqa_2
  s_sub_u32 s60, s95, 640
  v_mov_b32 v233, s60
  s_branch L_rqb_1
L_rqa_2:
  s_mov_b64 exec, 1
  global_atomic_add v233, v235, v234, s[24:25] sc0
  s_mov_b64 exec, -1
L_rqb_1:
  s_waitcnt vmcnt(24)
  ds_read_b128 v[140:143], v14 offset:16384
  ds_read_b128 v[144:147], v15 offset:16384
  ds_read_b128 v[148:151], v16 offset:16384
  ds_read_b128 v[152:155], v17 offset:16384
  ds_read_b128 v[156:159], v14 offset:20480
  ds_read_b128 v[160:163], v15 offset:20480
  ds_read_b128 v[164:167], v16 offset:20480
  ds_read_b128 v[168:171], v17 offset:20480
  s_waitcnt lgkmcnt(0)
  s_waitcnt vmcnt(16)
  ds_read_b64_tr_b16 v[172:173], v18 offset:16384
  ds_read_b64_tr_b16 v[174:175], v18 offset:20480
  ds_read_b64_tr_b16 v[176:177], v19 offset:16384
  ds_read_b64_tr_b16 v[178:179], v19 offset:20480
  ds_read_b64_tr_b16 v[180:181], v20 offset:16384
  ds_read_b64_tr_b16 v[182:183], v20 offset:20480
  ds_read_b64_tr_b16 v[184:185], v21 offset:16384
  ds_read_b64_tr_b16 v[186:187], v21 offset:20480
  ds_read_b64_tr_b16 v[188:189], v22 offset:16384
  ds_read_b64_tr_b16 v[190:191], v22 offset:20480
  ds_read_b64_tr_b16 v[192:193], v23 offset:16384
  ds_read_b64_tr_b16 v[194:195], v23 offset:20480
  ds_read_b64_tr_b16 v[196:197], v24 offset:16384
  ds_read_b64_tr_b16 v[198:199], v24 offset:20480
  ds_read_b64_tr_b16 v[200:201], v25 offset:16384
  ds_read_b64_tr_b16 v[202:203], v25 offset:20480
  s_waitcnt lgkmcnt(0)
  v_mfma_f32_16x16x32_bf16 v[204:207], v[76:79], v[28:31], 0
  v_mfma_f32_16x16x32_bf16 v[208:211], v[92:95], v[28:31], 0
  v_mfma_f32_16x16x32_bf16 v[204:207], v[80:83], v[32:35], v[204:207]
  v_mfma_f32_16x16x32_bf16 v[208:211], v[96:99], v[32:35], v[208:211]
  v_mfma_f32_16x16x32_bf16 v[204:207], v[84:87], v[36:39], v[204:207]
  v_mfma_f32_16x16x32_bf16 v[208:211], v[100:103], v[36:39], v[208:211]
  v_mfma_f32_16x16x32_bf16 v[204:207], v[88:91], v[40:43], v[204:207]
  v_mfma_f32_16x16x32_bf16 v[208:211], v[104:107], v[40:43], v[208:211]
  s_nop 7
  v_cvt_pk_bf16_f32 v229, v204, v205
  v_cvt_pk_bf16_f32 v230, v206, v207
  v_cvt_pk_bf16_f32 v231, v208, v209
  v_cvt_pk_bf16_f32 v232, v210, v211
  v_lshlrev_b32 v212, 16, v229
  v_and_b32 v213, 0xffff0000, v229
  v_lshlrev_b32 v214, 16, v230
  v_and_b32 v215, 0xffff0000, v230
  v_lshlrev_b32 v216, 16, v231
  v_and_b32 v217, 0xffff0000, v231
  v_lshlrev_b32 v218, 16, v232
  v_and_b32 v219, 0xffff0000, v232
  v_mul_f32 v212, s97, v212
  v_mul_f32 v213, s97, v213
  v_mul_f32 v214, s97, v214
  v_mul_f32 v215, s97, v215
  v_mul_f32 v216, s97, v216
  v_mul_f32 v217, s97, v217
  v_mul_f32 v218, s97, v218
  v_mul_f32 v219, s97, v219
  v_cvt_pk_bf16_f32 v229, v212, v213
  v_cvt_pk_bf16_f32 v230, v214, v215
  v_cvt_pk_bf16_f32 v231, v216, v217
  v_cvt_pk_bf16_f32 v232, v218, v219
  v_lshlrev_b32 v212, 16, v229
  v_and_b32 v213, 0xffff0000, v229
  v_lshlrev_b32 v214, 16, v230
  v_and_b32 v215, 0xffff0000, v230
  v_lshlrev_b32 v216, 16, v231
  v_and_b32 v217, 0xffff0000, v231
  v_lshlrev_b32 v218, 16, v232
  v_and_b32 v219, 0xffff0000, v232
  v_max3_f32 v228, v212, v213, v214
  v_max3_f32 v228, v228, v215, v216
  v_max3_f32 v228, v228, v217, v218
  v_max3_f32 v228, v228, v219, v224
  v_mov_b32 v229, v228
  s_nop 1
  v_permlane16_swap_b32 v228, v229
  s_nop 0
  v_max_f32 v228, v228, v229
  v_mov_b32 v229, v228
  s_nop 1
  v_permlane32_swap_b32 v228, v229
  s_nop 0
  v_max_f32 v228, v228, v229
  v_sub_f32 v226, v224, v228
  v_mul_f32 v226, s96, v226
  v_exp_f32 v226, v226
  v_mov_b32 v224, v228
  v_mul_f32 v227, s96, v228
  v_fma_f32 v212, v212, s96, -v227
  v_fma_f32 v213, v213, s96, -v227
  v_fma_f32 v214, v214, s96, -v227
  v_fma_f32 v215, v215, s96, -v227
  v_fma_f32 v216, v216, s96, -v227
  v_fma_f32 v217, v217, s96, -v227
  v_fma_f32 v218, v218, s96, -v227
  v_fma_f32 v219, v219, s96, -v227
  v_exp_f32 v212, v212
  v_exp_f32 v213, v213
  v_exp_f32 v214, v214
  v_exp_f32 v215, v215
  v_exp_f32 v216, v216
  v_exp_f32 v217, v217
  v_exp_f32 v218, v218
  v_exp_f32 v219, v219
  v_mul_f32 v225, v225, v226
  v_pk_mul_f32 v[44:45], v[44:45], v[226:227] op_sel_hi:[1,0]
  v_pk_mul_f32 v[46:47], v[46:47], v[226:227] op_sel_hi:[1,0]
  v_pk_mul_f32 v[48:49], v[48:49], v[226:227] op_sel_hi:[1,0]
  v_pk_mul_f32 v[50:51], v[50:51], v[226:227] op_sel_hi:[1,0]
  v_pk_mul_f32 v[52:53], v[52:53], v[226:227] op_sel_hi:[1,0]
  v_pk_mul_f32 v[54:55], v[54:55], v[226:227] op_sel_hi:[1,0]
  v_pk_mul_f32 v[56:57], v[56:57], v[226:227] op_sel_hi:[1,0]
  v_pk_mul_f32 v[58:59], v[58:59], v[226:227] op_sel_hi:[1,0]
  v_pk_mul_f32 v[60:61], v[60:61], v[226:227] op_sel_hi:[1,0]
  v_pk_mul_f32 v[62:63], v[62:63], v[226:227] op_sel_hi:[1,0]
  v_pk_mul_f32 v[64:65], v[64:65], v[226:227] op_sel_hi:[1,0]
  v_pk_mul_f32 v[66:67], v[66:67], v[226:227] op_sel_hi:[1,0]
  v_pk_mul_f32 v[68:69], v[68:69], v[226:227] op_sel_hi:[1,0]
  v_pk_mul_f32 v[70:71], v[70:71], v[226:227] op_sel_hi:[1,0]
  v_pk_mul_f32 v[72:73], v[72:73], v[226:227] op_sel_hi:[1,0]
  v_pk_mul_f32 v[74:75], v[74:75], v[226:227] op_sel_hi:[1,0]
  v_cvt_pk_bf16_f32 v220, v212, v213
  v_cvt_pk_bf16_f32 v221, v214, v215
  v_cvt_pk_bf16_f32 v222, v216, v217
  v_cvt_pk_bf16_f32 v223, v218, v219
  v_add_f32 v229, v212, v213
  v_add_f32 v230, v214, v215
  v_add_f32 v231, v216, v217
  v_add_f32 v232, v218, v219
  v_add_f32 v229, v229, v230
  v_add_f32 v231, v231, v232
  v_add_f32 v229, v229, v231
  v_add_f32 v225, v225, v229
  v_mfma_f32_16x16x32_bf16 v[44:47], v[108:111], v[220:223], v[44:47]
  v_mfma_f32_16x16x32_bf16 v[48:51], v[112:115], v[220:223], v[48:51]
  v_mfma_f32_16x16x32_bf16 v[52:55], v[116:119], v[220:223], v[52:55]
  v_mfma_f32_16x16x32_bf16 v[56:59], v[120:123], v[220:223], v[56:59]
  v_mfma_f32_16x16x32_bf16 v[60:63], v[124:127], v[220:223], v[60:63]
  v_mfma_f32_16x16x32_bf16 v[64:67], v[128:131], v[220:223], v[64:67]
  v_mfma_f32_16x16x32_bf16 v[68:71], v[132:135], v[220:223], v[68:71]
  v_mfma_f32_16x16x32_bf16 v[72:75], v[136:139], v[220:223], v[72:75]
  v_mfma_f32_16x16x32_bf16 v[204:207], v[140:143], v[28:31], 0
  v_mfma_f32_16x16x32_bf16 v[208:211], v[156:159], v[28:31], 0
  v_mfma_f32_16x16x32_bf16 v[204:207], v[144:147], v[32:35], v[204:207]
  v_mfma_f32_16x16x32_bf16 v[208:211], v[160:163], v[32:35], v[208:211]
  v_mfma_f32_16x16x32_bf16 v[204:207], v[148:151], v[36:39], v[204:207]
  v_mfma_f32_16x16x32_bf16 v[208:211], v[164:167], v[36:39], v[208:211]
  v_mfma_f32_16x16x32_bf16 v[204:207], v[152:155], v[40:43], v[204:207]
  v_mfma_f32_16x16x32_bf16 v[208:211], v[168:171], v[40:43], v[208:211]
  s_nop 7
  v_cvt_pk_bf16_f32 v229, v204, v205
  v_cvt_pk_bf16_f32 v230, v206, v207
  v_cvt_pk_bf16_f32 v231, v208, v209
  v_cvt_pk_bf16_f32 v232, v210, v211
  v_lshlrev_b32 v212, 16, v229
  v_and_b32 v213, 0xffff0000, v229
  v_lshlrev_b32 v214, 16, v230
  v_and_b32 v215, 0xffff0000, v230
  v_lshlrev_b32 v216, 16, v231
  v_and_b32 v217, 0xffff0000, v231
  v_lshlrev_b32 v218, 16, v232
  v_and_b32 v219, 0xffff0000, v232
  v_mul_f32 v212, s97, v212
  v_mul_f32 v213, s97, v213
  v_mul_f32 v214, s97, v214
  v_mul_f32 v215, s97, v215
  v_mul_f32 v216, s97, v216
  v_mul_f32 v217, s97, v217
  v_mul_f32 v218, s97, v218
  v_mul_f32 v219, s97, v219
  v_cvt_pk_bf16_f32 v229, v212, v213
  v_cvt_pk_bf16_f32 v230, v214, v215
  v_cvt_pk_bf16_f32 v231, v216, v217
  v_cvt_pk_bf16_f32 v232, v218, v219
  v_lshlrev_b32 v212, 16, v229
  v_and_b32 v213, 0xffff0000, v229
  v_lshlrev_b32 v214, 16, v230
  v_and_b32 v215, 0xffff0000, v230
  v_lshlrev_b32 v216, 16, v231
  v_and_b32 v217, 0xffff0000, v231
  v_lshlrev_b32 v218, 16, v232
  v_and_b32 v219, 0xffff0000, v232
  v_max3_f32 v228, v212, v213, v214
  v_max3_f32 v228, v228, v215, v216
  v_max3_f32 v228, v228, v217, v218
  v_max3_f32 v228, v228, v219, v224
  v_mov_b32 v229, v228
  s_nop 1
  v_permlane16_swap_b32 v228, v229
  s_nop 0
  v_max_f32 v228, v228, v229
  v_mov_b32 v229, v228
  s_nop 1
  v_permlane32_swap_b32 v228, v229
  s_nop 0
  v_max_f32 v228, v228, v229
  v_sub_f32 v226, v224, v228
  v_mul_f32 v226, s96, v226
  v_exp_f32 v226, v226
  v_mov_b32 v224, v228
  v_mul_f32 v227, s96, v228
  v_fma_f32 v212, v212, s96, -v227
  v_fma_f32 v213, v213, s96, -v227
  v_fma_f32 v214, v214, s96, -v227
  v_fma_f32 v215, v215, s96, -v227
  v_fma_f32 v216, v216, s96, -v227
  v_fma_f32 v217, v217, s96, -v227
  v_fma_f32 v218, v218, s96, -v227
  v_fma_f32 v219, v219, s96, -v227
  v_exp_f32 v212, v212
  v_exp_f32 v213, v213
  v_exp_f32 v214, v214
  v_exp_f32 v215, v215
  v_exp_f32 v216, v216
  v_exp_f32 v217, v217
  v_exp_f32 v218, v218
  v_exp_f32 v219, v219
  v_mul_f32 v225, v225, v226
  v_pk_mul_f32 v[44:45], v[44:45], v[226:227] op_sel_hi:[1,0]
  v_pk_mul_f32 v[46:47], v[46:47], v[226:227] op_sel_hi:[1,0]
  v_pk_mul_f32 v[48:49], v[48:49], v[226:227] op_sel_hi:[1,0]
  v_pk_mul_f32 v[50:51], v[50:51], v[226:227] op_sel_hi:[1,0]
  v_pk_mul_f32 v[52:53], v[52:53], v[226:227] op_sel_hi:[1,0]
  v_pk_mul_f32 v[54:55], v[54:55], v[226:227] op_sel_hi:[1,0]
  v_pk_mul_f32 v[56:57], v[56:57], v[226:227] op_sel_hi:[1,0]
  v_pk_mul_f32 v[58:59], v[58:59], v[226:227] op_sel_hi:[1,0]
  v_pk_mul_f32 v[60:61], v[60:61], v[226:227] op_sel_hi:[1,0]
  v_pk_mul_f32 v[62:63], v[62:63], v[226:227] op_sel_hi:[1,0]
  v_pk_mul_f32 v[64:65], v[64:65], v[226:227] op_sel_hi:[1,0]
  v_pk_mul_f32 v[66:67], v[66:67], v[226:227] op_sel_hi:[1,0]
  v_pk_mul_f32 v[68:69], v[68:69], v[226:227] op_sel_hi:[1,0]
  v_pk_mul_f32 v[70:71], v[70:71], v[226:227] op_sel_hi:[1,0]
  v_pk_mul_f32 v[72:73], v[72:73], v[226:227] op_sel_hi:[1,0]
  v_pk_mul_f32 v[74:75], v[74:75], v[226:227] op_sel_hi:[1,0]
  v_cvt_pk_bf16_f32 v220, v212, v213
  v_cvt_pk_bf16_f32 v221, v214, v215
  v_cvt_pk_bf16_f32 v222, v216, v217
  v_cvt_pk_bf16_f32 v223, v218, v219
  v_add_f32 v229, v212, v213
  v_add_f32 v230, v214, v215
  v_add_f32 v231, v216, v217
  v_add_f32 v232, v218, v219
  v_add_f32 v229, v229, v230
  v_add_f32 v231, v231, v232
  v_add_f32 v229, v229, v231
  v_add_f32 v225, v225, v229
  v_mfma_f32_16x16x32_bf16 v[44:47], v[172:175], v[220:223], v[44:47]
  v_mfma_f32_16x16x32_bf16 v[48:51], v[176:179], v[220:223], v[48:51]
  v_mfma_f32_16x16x32_bf16 v[52:55], v[180:183], v[220:223], v[52:55]
  v_mfma_f32_16x16x32_bf16 v[56:59], v[184:187], v[220:223], v[56:59]
  v_mfma_f32_16x16x32_bf16 v[60:63], v[188:191], v[220:223], v[60:63]
  v_mfma_f32_16x16x32_bf16 v[64:67], v[192:195], v[220:223], v[64:67]
  v_mfma_f32_16x16x32_bf16 v[68:71], v[196:199], v[220:223], v[68:71]
  v_mfma_f32_16x16x32_bf16 v[72:75], v[200:203], v[220:223], v[72:75]
  s_mov_b32 s93, 0
  s_cmp_ge_u32 s95, 640
  s_cselect_b32 s93, 1, 0
L_loop:
  s_waitcnt vmcnt(8)
  ds_read_b128 v[76:79], v14 offset:0
  ds_read_b128 v[80:83], v15 offset:0
  ds_read_b128 v[84:87], v16 offset:0
  ds_read_b128 v[88:91], v17 offset:0
  ds_read_b128 v[92:95], v14 offset:4096
  ds_read_b128 v[96:99], v15 offset:4096
  ds_read_b128 v[100:103], v16 offset:4096
  ds_read_b128 v[104:107], v17 offset:4096
  s_waitcnt lgkmcnt(0)
  s_waitcnt vmcnt(0)
  v_readfirstlane_b32 s99, v233
  s_add_u32 s99, s99, 640
  s_cmp_ge_u32 s99, 1024
  s_cbranch_scc1 L_last
  s_lshl_b32 s67, s99, 13
  s_add_u32 s67, s67, s98
  s_and_b32 s71, s67, 0x7fffff
  s_add_u32 s71, s71, s69
  s_add_u32 m0, s68, 0
  s_mov_b32 s60, s71
  buffer_load_dwordx4 v8, s[28:31], s60 offen offset:0 nt lds
  buffer_load_dwordx4 v9, s[28:31], s60 offen offset:1024 nt lds
  buffer_load_dwordx4 v10, s[28:31], s60 offen offset:2048 nt lds
  buffer_load_dwordx4 v11, s[28:31], s60 offen offset:3072 nt lds
  s_add_u32 m0, s68, 4096
  s_add_u32 s60, s71, 4096
  buffer_load_dwordx4 v8, s[28:31], s60 offen offset:0 nt lds
  buffer_load_dwordx4 v9, s[28:31], s60 offen offset:1024 nt lds
  buffer_load_dwordx4 v10, s[28:31], s60 offen offset:2048 nt lds
  buffer_load_dwordx4 v11, s[28:31], s60 offen offset:3072 nt lds
  ds_read_b64_tr_b16 v[108:109], v18 offset:0
  ds_read_b64_tr_b16 v[110:111], v18 offset:4096
  ds_read_b64_tr_b16 v[112:113], v19 offset:0
  ds_read_b64_tr_b16 v[114:115], v19 offset:4096
  ds_read_b64_tr_b16 v[116:117], v20 offset:0
  ds_read_b64_tr_b16 v[118:119], v20 offset:4096
  ds_read_b64_tr_b16 v[120:121], v21 offset:0
  ds_read_b64_tr_b16 v[122:123], v21 offset:4096
  ds_read_b64_tr_b16 v[124:125], v22 offset:0
  ds_read_b64_tr_b16 v[126:127], v22 offset:4096
  ds_read_b64_tr_b16 v[128:129], v23 offset:0
  ds_read_b64_tr_b16 v[130:131], v23 offset:4096
  ds_read_b64_tr_b16 v[132:133], v24 offset:0
  ds_read_b64_tr_b16 v[134:135], v24 offset:4096
  ds_read_b64_tr_b16 v[136:137], v25 offset:0
  ds_read_b64_tr_b16 v[138:139], v25 offset:4096
  s_waitcnt lgkmcnt(0)
  s_add_u32 m0, s68, 8192
  s_mov_b32 s60, s71
  buffer_load_dwordx4 v12, s[32:35], s60 offen offset:0 nt lds
  buffer_load_dwordx4 v13, s[32:35], s60 offen offset:1024 nt lds
  buffer_load_dwordx4 v12, s[32:35], s60 offen offset:2048 nt lds
  buffer_load_dwordx4 v13, s[32:35], s60 offen offset:3072 nt lds
  s_add_u32 m0, s68, 12288
  s_add_u32 s60, s71, 4096
  buffer_load_dwordx4 v12, s[32:35], s60 offen offset:0 nt lds
  buffer_load_dwordx4 v13, s[32:35], s60 offen offset:1024 nt lds
  buffer_load_dwordx4 v12, s[32:35], s60 offen offset:2048 nt lds
  buffer_load_dwordx4 v13, s[32:35], s60 offen offset:3072 nt lds
  s_add_u32 s70, s70, 1
L_comp:
  v_mfma_f32_16x16x32_bf16 v[204:207], v[76:79], v[28:31], 0
  v_mfma_f32_16x16x32_bf16 v[208:211], v[92:95], v[28:31], 0
  v_mfma_f32_16x16x32_bf16 v[204:207], v[80:83], v[32:35], v[204:207]
  v_mfma_f32_16x16x32_bf16 v[208:211], v[96:99], v[32:35], v[208:211]
  v_mfma_f32_16x16x32_bf16 v[204:207], v[84:87], v[36:39], v[204:207]
  v_mfma_f32_16x16x32_bf16 v[208:211], v[100:103], v[36:39], v[208:211]
  v_mfma_f32_16x16x32_bf16 v[204:207], v[88:91], v[40:43], v[204:207]
  v_mfma_f32_16x16x32_bf16 v[208:211], v[104:107], v[40:43], v[208:211]
  s_nop 7
  v_cvt_pk_bf16_f32 v229, v204, v205
  v_cvt_pk_bf16_f32 v230, v206, v207
  v_cvt_pk_bf16_f32 v231, v208, v209
  v_cvt_pk_bf16_f32 v232, v210, v211
  v_lshlrev_b32 v212, 16, v229
  v_and_b32 v213, 0xffff0000, v229
  v_lshlrev_b32 v214, 16, v230
  v_and_b32 v215, 0xffff0000, v230
  v_lshlrev_b32 v216, 16, v231
  v_and_b32 v217, 0xffff0000, v231
  v_lshlrev_b32 v218, 16, v232
  v_and_b32 v219, 0xffff0000, v232
  v_mul_f32 v212, s97, v212
  v_mul_f32 v213, s97, v213
  v_mul_f32 v214, s97, v214
  v_mul_f32 v215, s97, v215
  v_mul_f32 v216, s97, v216
  v_mul_f32 v217, s97, v217
  v_mul_f32 v218, s97, v218
  v_mul_f32 v219, s97, v219
  v_cvt_pk_bf16_f32 v229, v212, v213
  v_cvt_pk_bf16_f32 v230, v214, v215
  v_cvt_pk_bf16_f32 v231, v216, v217
  v_cvt_pk_bf16_f32 v232, v218, v219
  v_lshlrev_b32 v212, 16, v229
  v_and_b32 v213, 0xffff0000, v229
  v_lshlrev_b32 v214, 16, v230
  v_and_b32 v215, 0xffff0000, v230
  v_lshlrev_b32 v216, 16, v231
  v_and_b32 v217, 0xffff0000, v231
  v_lshlrev_b32 v218, 16, v232
  v_and_b32 v219, 0xffff0000, v232
  v_max3_f32 v228, v212, v213, v214
  v_max3_f32 v228, v228, v215, v216
  v_max3_f32 v228, v228, v217, v218
  v_max3_f32 v228, v228, v219, v224
  v_mov_b32 v229, v228
  s_nop 1
  v_permlane16_swap_b32 v228, v229
  s_nop 0
  v_max_f32 v228, v228, v229
  v_mov_b32 v229, v228
  s_nop 1
  v_permlane32_swap_b32 v228, v229
  s_nop 0
  v_max_f32 v228, v228, v229
  v_sub_f32 v226, v224, v228
  v_mul_f32 v226, s96, v226
  v_exp_f32 v226, v226
  v_mov_b32 v224, v228
  v_mul_f32 v227, s96, v228
  v_fma_f32 v212, v212, s96, -v227
  v_fma_f32 v213, v213, s96, -v227
  v_fma_f32 v214, v214, s96, -v227
  v_fma_f32 v215, v215, s96, -v227
  v_fma_f32 v216, v216, s96, -v227
  v_fma_f32 v217, v217, s96, -v227
  v_fma_f32 v218, v218, s96, -v227
  v_fma_f32 v219, v219, s96, -v227
  v_exp_f32 v212, v212
  v_exp_f32 v213, v213
  v_exp_f32 v214, v214
  v_exp_f32 v215, v215
  v_exp_f32 v216, v216
  v_exp_f32 v217, v217
  v_exp_f32 v218, v218
  v_exp_f32 v219, v219
  v_mul_f32 v225, v225, v226
  v_pk_mul_f32 v[44:45], v[44:45], v[226:227] op_sel_hi:[1,0]
  v_pk_mul_f32 v[46:47], v[46:47], v[226:227] op_sel_hi:[1,0]
  v_pk_mul_f32 v[48:49], v[48:49], v[226:227] op_sel_hi:[1,0]
  v_pk_mul_f32 v[50:51], v[50:51], v[226:227] op_sel_hi:[1,0]
  v_pk_mul_f32 v[52:53], v[52:53], v[226:227] op_sel_hi:[1,0]
  v_pk_mul_f32 v[54:55], v[54:55], v[226:227] op_sel_hi:[1,0]
  v_pk_mul_f32 v[56:57], v[56:57], v[226:227] op_sel_hi:[1,0]
  v_pk_mul_f32 v[58:59], v[58:59], v[226:227] op_sel_hi:[1,0]
  v_pk_mul_f32 v[60:61], v[60:61], v[226:227] op_sel_hi:[1,0]
  v_pk_mul_f32 v[62:63], v[62:63], v[226:227] op_sel_hi:[1,0]
  v_pk_mul_f32 v[64:65], v[64:65], v[226:227] op_sel_hi:[1,0]
  v_pk_mul_f32 v[66:67], v[66:67], v[226:227] op_sel_hi:[1,0]
  v_pk_mul_f32 v[68:69], v[68:69], v[226:227] op_sel_hi:[1,0]
  v_pk_mul_f32 v[70:71], v[70:71], v[226:227] op_sel_hi:[1,0]
  v_pk_mul_f32 v[72:73], v[72:73], v[226:227] op_sel_hi:[1,0]
  v_pk_mul_f32 v[74:75], v[74:75], v[226:227] op_sel_hi:[1,0]
  v_cvt_pk_bf16_f32 v220, v212, v213
  v_cvt_pk_bf16_f32 v221, v214, v215
  v_cvt_pk_bf16_f32 v222, v216, v217
  v_cvt_pk_bf16_f32 v223, v218, v219
  v_add_f32 v229, v212, v213
  v_add_f32 v230, v214, v215
  v_add_f32 v231, v216, v217
  v_add_f32 v232, v218, v219
  v_add_f32 v229, v229, v230
  v_add_f32 v231, v231, v232
  v_add_f32 v229, v229, v231
  v_add_f32 v225, v225, v229
  v_mfma_f32_16x16x32_bf16 v[44:47], v[108:111], v[220:223], v[44:47]
  v_mfma_f32_16x16x32_bf16 v[48:51], v[112:115], v[220:223], v[48:51]
  v_mfma_f32_16x16x32_bf16 v[52:55], v[116:119], v[220:223], v[52:55]
  v_mfma_f32_16x16x32_bf16 v[56:59], v[120:123], v[220:223], v[56:59]
  v_mfma_f32_16x16x32_bf16 v[60:63], v[124:127], v[220:223], v[60:63]
  v_mfma_f32_16x16x32_bf16 v[64:67], v[128:131], v[220:223], v[64:67]
  v_mfma_f32_16x16x32_bf16 v[68:71], v[132:135], v[220:223], v[68:71]
  v_mfma_f32_16x16x32_bf16 v[72:75], v[136:139], v[220:223], v[72:75]
  s_cmp_eq_u32 s73, 1
  s_cbranch_scc1 L_ldone
  s_add_u32 s95, s95, 64
  s_cmp_ge_u32 s95, 640
  s_cbranch_scc1 L_rqa_4
  s_sub_u32 s60, s95, 640
  v_mov_b32 v233, s60
  s_branch L_rqb_3
L_rqa_4:
  s_mov_b64 exec, 1
  global_atomic_add v233, v235, v234, s[24:25] sc0
  s_mov_b64 exec, -1
L_rqb_3:
  s_cmp_ge_u32 s95, 640
  s_cselect_b32 s93, 1, 0
  s_branch L_loop
L_last:
  s_mov_b32 s73, 1
  ds_read_b64_tr_b16 v[108:109], v18 offset:0
  ds_read_b64_tr_b16 v[110:111], v18 offset:4096
  ds_read_b64_tr_b16 v[112:113], v19 offset:0
  ds_read_b64_tr_b16 v[114:115], v19 offset:4096
  ds_read_b64_tr_b16 v[116:117], v20 offset:0
  ds_read_b64_tr_b16 v[118:119], v20 offset:4096
  ds_read_b64_tr_b16 v[120:121], v21 offset:0
  ds_read_b64_tr_b16 v[122:123], v21 offset:4096
  ds_read_b64_tr_b16 v[124:125], v22 offset:0
  ds_read_b64_tr_b16 v[126:127], v22 offset:4096
  ds_read_b64_tr_b16 v[128:129], v23 offset:0
  ds_read_b64_tr_b16 v[130:131], v23 offset:4096
  ds_read_b64_tr_b16 v[132:133], v24 offset:0
  ds_read_b64_tr_b16 v[134:135], v24 offset:4096
  ds_read_b64_tr_b16 v[136:137], v25 offset:0
  ds_read_b64_tr_b16 v[138:139], v25 offset:4096
  s_waitcnt lgkmcnt(0)
  s_branch L_comp
L_ldone:
  v_mov_b32 v229, v225
  s_nop 1
  v_permlane16_swap_b32 v225, v229
  s_nop 0
  v_add_f32 v225, v225, v229
  v_mov_b32 v229, v225
  s_nop 1
  v_permlane32_swap_b32 v225, v229
  s_nop 0
  v_add_f32 v225, v225, v229
  v_and_b32 v1, 15, v0
  v_lshrrev_b32 v2, 4, v0
  v_lshlrev_b32 v3, 9, v1
  v_lshl_add_u32 v3, v2, 4, v3
  v_add_u32 v3, s68, v3
  s_lshl_b32 s60, s3, 5
  s_add_u32 s60, s60, 153600
  v_lshlrev_b32 v4, 3, v1
  v_add_u32 v4, s60, v4
  s_nop 7
  s_mov_b64 exec, s[74:75]
  ds_write_b128 v3, v[44:47] offset:0
  ds_write_b128 v3, v[48:51] offset:64
  ds_write_b128 v3, v[52:55] offset:128
  ds_write_b128 v3, v[56:59] offset:192
  ds_write_b128 v3, v[60:63] offset:256
  ds_write_b128 v3, v[64:67] offset:320
  ds_write_b128 v3, v[68:71] offset:384
  ds_write_b128 v3, v[72:75] offset:448
  ds_write_b64 v4, v[224:225]
  s_mov_b64 exec, -1
  s_mov_b64 s[62:63], s[4:5]
  v_mov_b32 v228, 0
  v_mov_b32 v229, 0
  v_mov_b32 v231, 0
  v_mov_b32 v232, 0
  v_mov_b32 v233, 0
  v_mov_b32 v234, 0
  v_mov_b32 v235, 0
  s_waitcnt lgkmcnt(0)
  s_branch L_tail
L_helper:
  s_setprio 3
  s_sub_u32 s65, s3, 4
  s_lshl_b32 s65, s65, 12
  s_add_u32 s65, s65, 131072
  s_cmp_ge_u32 s3, 6
  s_cbranch_scc1 L_w67
  s_and_b32 s62, s2, 3
  s_lshr_b32 s61, s2, 2
  v_lshrrev_b32 v2, 3, v0
  v_and_b32 v3, 7, v0
  v_lshlrev_b32 v1, 4, v0
  s_cmp_eq_u32 s3, 5
  s_cbranch_scc1 L_w5setup
  s_mov_b32 s60, 8192
  s_mov_b32 s63, 147456
  s_mov_b32 s96, 2097152
  s_mov_b32 s97, 32768
  s_waitcnt lgkmcnt(0)
  s_mov_b32 s40, s10
  s_and_b32 s41, s11, 0xffff
  s_mov_b32 s42, 0x400000
  s_mov_b32 s43, 0x20000
  s_and_b32 s64, s2, 30
  s_cmp_lg_u32 s64, 0
  s_cbranch_scc1 L_slice
  s_and_b32 s64, s2, 1
  s_lshl_b32 s64, s64, 3
  s_lshr_b32 s71, s2, 5
  s_add_u32 s64, s64, s71
  s_lshl_b32 s64, s64, 8
  s_add_u32 s64, s64, 2752512
  v_mov_b32 v4, s64
  v_mov_b32 v5, 0
  s_mov_b64 exec, 1
  global_store_dword v4, v5, s[24:25] sc1
  s_mov_b64 exec, -1
  s_branch L_slice
L_w5setup:
  s_mov_b32 s60, 3584
  s_mov_b32 s63, 149504
  s_mov_b32 s96, 2359296
  s_mov_b32 s97, 14336
  s_waitcnt lgkmcnt(0)
  s_mov_b32 s40, s16
  s_and_b32 s41, s17, 0xffff
  s_mov_b32 s42, 0x1c0000
  s_mov_b32 s43, 0x20000
  s_cmp_ge_u32 s57, 7
  s_cbranch_scc1 L_hb0
  s_mul_i32 s61, s56, 7
  s_add_u32 s61, s61, s57
  s_and_b32 s62, s61, 3
  s_lshr_b32 s61, s61, 2
L_slice:
  s_mov_b32 s44, s4
  s_and_b32 s45, s5, 0xffff
  s_mov_b32 s46, 0x800
  s_mov_b32 s47, 0x20000
  buffer_load_dwordx4 v[8:11], v1, s[44:47], 0 offen
  buffer_load_dwordx4 v[12:15], v1, s[44:47], 0 offen offset:1024
  v_mul_lo_u32 v2, v2, s60
  v_lshl_add_u32 v2, v3, 4, v2
  s_lshl_b32 s71, s62, 7
  s_mul_i32 s71, s71, s60
  s_lshl_b32 s64, s61, 7
  s_add_u32 s71, s71, s64
  s_lshl_b32 s72, s60, 3
  buffer_load_dwordx4 v[64:67], v2, s[40:43], s71 offen nt
  s_add_u32 s71, s71, s72
  buffer_load_dwordx4 v[68:71], v2, s[40:43], s71 offen nt
  s_add_u32 s71, s71, s72
  buffer_load_dwordx4 v[72:75], v2, s[40:43], s71 offen nt
  s_add_u32 s71, s71, s72
  buffer_load_dwordx4 v[76:79], v2, s[40:43], s71 offen nt
  s_add_u32 s71, s71, s72
  buffer_load_dwordx4 v[80:83], v2, s[40:43], s71 offen nt
  s_add_u32 s71, s71, s72
  buffer_load_dwordx4 v[84:87], v2, s[40:43], s71 offen nt
  s_add_u32 s71, s71, s72
  buffer_load_dwordx4 v[88:91], v2, s[40:43], s71 offen nt
  s_add_u32 s71, s71, s72
  buffer_load_dwordx4 v[92:95], v2, s[40:43], s71 offen nt
  s_add_u32 s71, s71, s72
  buffer_load_dwordx4 v[96:99], v2, s[40:43], s71 offen nt
  s_add_u32 s71, s71, s72
  buffer_load_dwordx4 v[100:103], v2, s[40:43], s71 offen nt
  s_add_u32 s71, s71, s72
  buffer_load_dwordx4 v[104:107], v2, s[40:43], s71 offen nt
  s_add_u32 s71, s71, s72
  buffer_load_dwordx4 v[108:111], v2, s[40:43], s71 offen nt
  s_add_u32 s71, s71, s72
  buffer_load_dwordx4 v[112:115], v2, s[40:43], s71 offen nt
  s_add_u32 s71, s71, s72
  buffer_load_dwordx4 v[116:119], v2, s[40:43], s71 offen nt
  s_add_u32 s71, s71, s72
  buffer_load_dwordx4 v[120:123], v2, s[40:43], s71 offen nt
  s_add_u32 s71, s71, s72
  buffer_load_dwordx4 v[124:127], v2, s[40:43], s71 offen nt
  s_barrier
  s_load_dword s27, s[24:25], 0
  s_mov_b32 s36, s24
  s_and_b32 s37, s25, 0xffff
  s_mov_b32 s38, 0x800000
  s_mov_b32 s39, 0x20000
  s_mov_b32 s52, s12
  s_and_b32 s53, s13, 0xffff
  s_mov_b32 s54, 0x400000
  s_mov_b32 s55, 0x20000
  s_mov_b32 s48, s20
  s_and_b32 s49, s21, 0xffff
  s_mov_b32 s50, 0x800
  s_mov_b32 s51, 0x20000
  s_waitcnt vmcnt(16)
  v_lshlrev_b32 v16, 16, v8
  v_and_b32 v17, 0xffff0000, v8
  v_lshlrev_b32 v18, 16, v9
  v_and_b32 v19, 0xffff0000, v9
  v_lshlrev_b32 v20, 16, v10
  v_and_b32 v21, 0xffff0000, v10
  v_lshlrev_b32 v22, 16, v11
  v_and_b32 v23, 0xffff0000, v11
  v_lshlrev_b32 v24, 16, v12
  v_and_b32 v25, 0xffff0000, v12
  v_lshlrev_b32 v26, 16, v13
  v_and_b32 v27, 0xffff0000, v13
  v_lshlrev_b32 v28, 16, v14
  v_and_b32 v29, 0xffff0000, v14
  v_lshlrev_b32 v30, 16, v15
  v_and_b32 v31, 0xffff0000, v15
  v_add_f32 v32, v16, v17
  v_add_f32 v32, v32, v18
  v_add_f32 v32, v32, v19
  v_add_f32 v32, v32, v20
  v_add_f32 v32, v32, v21
  v_add_f32 v32, v32, v22
  v_add_f32 v32, v32, v23
  v_add_f32 v33, v24, v25
  v_add_f32 v33, v33, v26
  v_add_f32 v33, v33, v27
  v_add_f32 v33, v33, v28
  v_add_f32 v33, v33, v29
  v_add_f32 v33, v33, v30
  v_add_f32 v33, v33, v31
  s_nop 1
  v_add_f32_dpp v32, v32, v32 row_ror:1 row_mask:0xf bank_mask:0xf
  v_add_f32_dpp v33, v33, v33 row_ror:1 row_mask:0xf bank_mask:0xf
  s_nop 1
  v_add_f32_dpp v32, v32, v32 row_ror:2 row_mask:0xf bank_mask:0xf
  v_add_f32_dpp v33, v33, v33 row_ror:2 row_mask:0xf bank_mask:0xf
  s_nop 1
  v_add_f32_dpp v32, v32, v32 row_ror:4 row_mask:0xf bank_mask:0xf
  v_add_f32_dpp v33, v33, v33 row_ror:4 row_mask:0xf bank_mask:0xf
  s_nop 1
  v_add_f32_dpp v32, v32, v32 row_ror:8 row_mask:0xf bank_mask:0xf
  v_add_f32_dpp v33, v33, v33 row_ror:8 row_mask:0xf bank_mask:0xf
  s_nop 0
  v_mov_b32 v34, v32
  v_mov_b32 v35, v33
  s_nop 0
  s_nop 0
  v_permlane16_swap_b32 v32, v34
  v_permlane16_swap_b32 v33, v35
  s_nop 0
  v_add_f32 v32, v32, v34
  v_add_f32 v33, v33, v35
  s_nop 0
  v_mov_b32 v34, v32
  v_mov_b32 v35, v33
  s_nop 0
  s_nop 0
  v_permlane32_swap_b32 v32, v34
  v_permlane32_swap_b32 v33, v35
  s_nop 0
  v_add_f32 v32, v32, v34
  v_add_f32 v33, v33, v35
  s_nop 0
  s_mov_b32 s64, 0x3b000000
  v_mul_f32 v32, s64, v32
  v_mul_f32 v33, s64, v33
  v_sub_f32 v40, v16, v32
  v_mul_f32 v36, v40, v40
  v_sub_f32 v40, v17, v32
  v_fmac_f32 v36, v40, v40
  v_sub_f32 v40, v18, v32
  v_fmac_f32 v36, v40, v40
  v_sub_f32 v40, v19, v32
  v_fmac_f32 v36, v40, v40
  v_sub_f32 v40, v20, v32
  v_fmac_f32 v36, v40, v40
  v_sub_f32 v40, v21, v32
  v_fmac_f32 v36, v40, v40
  v_sub_f32 v40, v22, v32
  v_fmac_f32 v36, v40, v40
  v_sub_f32 v40, v23, v32
  v_fmac_f32 v36, v40, v40
  v_sub_f32 v40, v24, v33
  v_mul_f32 v37, v40, v40
  v_sub_f32 v40, v25, v33
  v_fmac_f32 v37, v40, v40
  v_sub_f32 v40, v26, v33
  v_fmac_f32 v37, v40, v40
  v_sub_f32 v40, v27, v33
  v_fmac_f32 v37, v40, v40
  v_sub_f32 v40, v28, v33
  v_fmac_f32 v37, v40, v40
  v_sub_f32 v40, v29, v33
  v_fmac_f32 v37, v40, v40
  v_sub_f32 v40, v30, v33
  v_fmac_f32 v37, v40, v40
  v_sub_f32 v40, v31, v33
  v_fmac_f32 v37, v40, v40
  s_nop 1
  v_add_f32_dpp v36, v36, v36 row_ror:1 row_mask:0xf bank_mask:0xf
  v_add_f32_dpp v37, v37, v37 row_ror:1 row_mask:0xf bank_mask:0xf
  s_nop 1
  v_add_f32_dpp v36, v36, v36 row_ror:2 row_mask:0xf bank_mask:0xf
  v_add_f32_dpp v37, v37, v37 row_ror:2 row_mask:0xf bank_mask:0xf
  s_nop 1
  v_add_f32_dpp v36, v36, v36 row_ror:4 row_mask:0xf bank_mask:0xf
  v_add_f32_dpp v37, v37, v37 row_ror:4 row_mask:0xf bank_mask:0xf
  s_nop 1
  v_add_f32_dpp v36, v36, v36 row_ror:8 row_mask:0xf bank_mask:0xf
  v_add_f32_dpp v37, v37, v37 row_ror:8 row_mask:0xf bank_mask:0xf
  s_nop 0
  v_mov_b32 v38, v36
  v_mov_b32 v39, v37
  s_nop 0
  s_nop 0
  v_permlane16_swap_b32 v36, v38
  v_permlane16_swap_b32 v37, v39
  s_nop 0
  v_add_f32 v36, v36, v38
  v_add_f32 v37, v37, v39
  s_nop 0
  v_mov_b32 v38, v36
  v_mov_b32 v39, v37
  s_nop 0
  s_nop 0
  v_permlane32_swap_b32 v36, v38
  v_permlane32_swap_b32 v37, v39
  s_nop 0
  v_add_f32 v36, v36, v38
  v_add_f32 v37, v37, v39
  s_nop 0
  v_mul_f32 v36, s64, v36
  v_mul_f32 v37, s64, v37
  v_cvt_pk_bf16_f32 v40, v32, v33
  v_cvt_pk_bf16_f32 v41, v36, v37
  v_lshlrev_b32 v32, 16, v40
  v_and_b32 v33, 0xffff0000, v40
  v_lshlrev_b32 v36, 16, v41
  v_and_b32 v37, 0xffff0000, v41
  v_add_f32 v36, 0x3727c5ac, v36
  v_add_f32 v37, 0x3727c5ac, v37
  v_cvt_pk_bf16_f32 v41, v36, v37
  v_lshlrev_b32 v36, 16, v41
  v_and_b32 v37, 0xffff0000, v41
  v_sqrt_f32 v36, v36
  v_sqrt_f32 v37, v37
  s_nop 0
  v_cvt_pk_bf16_f32 v41, v36, v37
  v_lshlrev_b32 v36, 16, v41
  v_and_b32 v37, 0xffff0000, v41
  v_rcp_f32 v38, v36
  v_rcp_f32 v39, v37
  v_sub_f32 v16, v16, v32
  v_sub_f32 v17, v17, v32
  v_sub_f32 v18, v18, v32
  v_sub_f32 v19, v19, v32
  v_sub_f32 v20, v20, v32
  v_sub_f32 v21, v21, v32
  v_sub_f32 v22, v22, v32
  v_sub_f32 v23, v23, v32
  v_cvt_pk_bf16_f32 v40, v16, v17
  v_lshlrev_b32 v16, 16, v40
  v_and_b32 v17, 0xffff0000, v40
  v_cvt_pk_bf16_f32 v40, v18, v19
  v_lshlrev_b32 v18, 16, v40
  v_and_b32 v19, 0xffff0000, v40
  v_cvt_pk_bf16_f32 v40, v20, v21
  v_lshlrev_b32 v20, 16, v40
  v_and_b32 v21, 0xffff0000, v40
  v_cvt_pk_bf16_f32 v40, v22, v23
  v_lshlrev_b32 v22, 16, v40
  v_and_b32 v23, 0xffff0000, v40
  v_mul_f32 v41, v16, v38
  v_fma_f32 v42, -v41, v36, v16
  v_fma_f32 v16, v42, v38, v41
  v_mul_f32 v41, v17, v38
  v_fma_f32 v42, -v41, v36, v17
  v_fma_f32 v17, v42, v38, v41
  v_mul_f32 v41, v18, v38
  v_fma_f32 v42, -v41, v36, v18
  v_fma_f32 v18, v42, v38, v41
  v_mul_f32 v41, v19, v38
  v_fma_f32 v42, -v41, v36, v19
  v_fma_f32 v19, v42, v38, v41
  v_mul_f32 v41, v20, v38
  v_fma_f32 v42, -v41, v36, v20
  v_fma_f32 v20, v42, v38, v41
  v_mul_f32 v41, v21, v38
  v_fma_f32 v42, -v41, v36, v21
  v_fma_f32 v21, v42, v38, v41
  v_mul_f32 v41, v22, v38
  v_fma_f32 v42, -v41, v36, v22
  v_fma_f32 v22, v42, v38, v41
  v_mul_f32 v41, v23, v38
  v_fma_f32 v42, -v41, v36, v23
  v_fma_f32 v23, v42, v38, v41
  v_cvt_pk_bf16_f32 v44, v16, v17
  v_cvt_pk_bf16_f32 v45, v18, v19
  v_cvt_pk_bf16_f32 v46, v20, v21
  v_cvt_pk_bf16_f32 v47, v22, v23
  v_sub_f32 v24, v24, v33
  v_sub_f32 v25, v25, v33
  v_sub_f32 v26, v26, v33
  v_sub_f32 v27, v27, v33
  v_sub_f32 v28, v28, v33
  v_sub_f32 v29, v29, v33
  v_sub_f32 v30, v30, v33
  v_sub_f32 v31, v31, v33
  v_cvt_pk_bf16_f32 v40, v24, v25
  v_lshlrev_b32 v24, 16, v40
  v_and_b32 v25, 0xffff0000, v40
  v_cvt_pk_bf16_f32 v40, v26, v27
  v_lshlrev_b32 v26, 16, v40
  v_and_b32 v27, 0xffff0000, v40
  v_cvt_pk_bf16_f32 v40, v28, v29
  v_lshlrev_b32 v28, 16, v40
  v_and_b32 v29, 0xffff0000, v40
  v_cvt_pk_bf16_f32 v40, v30, v31
  v_lshlrev_b32 v30, 16, v40
  v_and_b32 v31, 0xffff0000, v40
  v_mul_f32 v41, v24, v39
  v_fma_f32 v42, -v41, v37, v24
  v_fma_f32 v24, v42, v39, v41
  v_mul_f32 v41, v25, v39
  v_fma_f32 v42, -v41, v37, v25
  v_fma_f32 v25, v42, v39, v41
  v_mul_f32 v41, v26, v39
  v_fma_f32 v42, -v41, v37, v26
  v_fma_f32 v26, v42, v39, v41
  v_mul_f32 v41, v27, v39
  v_fma_f32 v42, -v41, v37, v27
  v_fma_f32 v27, v42, v39, v41
  v_mul_f32 v41, v28, v39
  v_fma_f32 v42, -v41, v37, v28
  v_fma_f32 v28, v42, v39, v41
  v_mul_f32 v41, v29, v39
  v_fma_f32 v42, -v41, v37, v29
  v_fma_f32 v29, v42, v39, v41
  v_mul_f32 v41, v30, v39
  v_fma_f32 v42, -v41, v37, v30
  v_fma_f32 v30, v42, v39, v41
  v_mul_f32 v41, v31, v39
  v_fma_f32 v42, -v41, v37, v31
  v_fma_f32 v31, v42, v39, v41
  v_cvt_pk_bf16_f32 v48, v24, v25
  v_cvt_pk_bf16_f32 v49, v26, v27
  v_cvt_pk_bf16_f32 v50, v28, v29
  v_cvt_pk_bf16_f32 v51, v30, v31
  v_lshlrev_b32 v1, 4, v0
  v_add_u32 v1, s63, v1
  ds_write_b128 v1, v[44:47]
  ds_write_b128 v1, v[48:51] offset:1024
  v_lshlrev_b32 v1, 4, v0
  v_add_u32 v1, s65, v1
  v_lshrrev_b32 v2, 4, v0
  v_bfe_u32 v3, v0, 2, 2
  v_lshl_add_u32 v3, v2, 3, v3
  v_and_b32 v4, 3, v0
  v_lshlrev_b32 v5, 7, v3
  v_lshl_add_u32 v5, v4, 3, v5
  v_add_u32 v5, s65, v5
  v_and_b32 v6, 1, v0
  v_lshlrev_b32 v6, 10, v6
  v_lshl_add_u32 v6, v2, 4, v6
  s_lshl_b32 s64, s62, 8
  s_add_u32 s64, s64, s63
  v_add_u32 v6, s64, v6
  ds_read_b128 v[16:19], v6 offset:0
  ds_read_b128 v[20:23], v6 offset:64
  ds_read_b128 v[24:27], v6 offset:128
  ds_read_b128 v[28:31], v6 offset:192
  s_waitcnt vmcnt(12)
  ds_write_b128 v1, v[64:67] offset:0
  ds_write_b128 v1, v[68:71] offset:1024
  ds_write_b128 v1, v[72:75] offset:2048
  ds_write_b128 v1, v[76:79] offset:3072
  ds_read_b64_tr_b16 v[32:33], v5 offset:0
  ds_read_b64_tr_b16 v[34:35], v5 offset:512
  ds_read_b64_tr_b16 v[36:37], v5 offset:32
  ds_read_b64_tr_b16 v[38:39], v5 offset:544
  ds_read_b64_tr_b16 v[40:41], v5 offset:64
  ds_read_b64_tr_b16 v[42:43], v5 offset:576
  ds_read_b64_tr_b16 v[44:45], v5 offset:96
  ds_read_b64_tr_b16 v[46:47], v5 offset:608
  s_waitcnt lgkmcnt(0)
  v_mfma_f32_16x16x32_bf16 v[48:51], v[16:19], v[32:35], 0
  v_mfma_f32_16x16x32_bf16 v[52:55], v[16:19], v[36:39], 0
  v_mfma_f32_16x16x32_bf16 v[56:59], v[16:19], v[40:43], 0
  v_mfma_f32_16x16x32_bf16 v[60:63], v[16:19], v[44:47], 0
  s_waitcnt vmcnt(8)
  ds_write_b128 v1, v[80:83] offset:0
  ds_write_b128 v1, v[84:87] offset:1024
  ds_write_b128 v1, v[88:91] offset:2048
  ds_write_b128 v1, v[92:95] offset:3072
  ds_read_b64_tr_b16 v[32:33], v5 offset:0
  ds_read_b64_tr_b16 v[34:35], v5 offset:512
  ds_read_b64_tr_b16 v[36:37], v5 offset:32
  ds_read_b64_tr_b16 v[38:39], v5 offset:544
  ds_read_b64_tr_b16 v[40:41], v5 offset:64
  ds_read_b64_tr_b16 v[42:43], v5 offset:576
  ds_read_b64_tr_b16 v[44:45], v5 offset:96
  ds_read_b64_tr_b16 v[46:47], v5 offset:608
  s_waitcnt lgkmcnt(0)
  v_mfma_f32_16x16x32_bf16 v[48:51], v[20:23], v[32:35], v[48:51]
  v_mfma_f32_16x16x32_bf16 v[52:55], v[20:23], v[36:39], v[52:55]
  v_mfma_f32_16x16x32_bf16 v[56:59], v[20:23], v[40:43], v[56:59]
  v_mfma_f32_16x16x32_bf16 v[60:63], v[20:23], v[44:47], v[60:63]
  s_waitcnt vmcnt(4)
  ds_write_b128 v1, v[96:99] offset:0
  ds_write_b128 v1, v[100:103] offset:1024
  ds_write_b128 v1, v[104:107] offset:2048
  ds_write_b128 v1, v[108:111] offset:3072
  ds_read_b64_tr_b16 v[32:33], v5 offset:0
  ds_read_b64_tr_b16 v[34:35], v5 offset:512
  ds_read_b64_tr_b16 v[36:37], v5 offset:32
  ds_read_b64_tr_b16 v[38:39], v5 offset:544
  ds_read_b64_tr_b16 v[40:41], v5 offset:64
  ds_read_b64_tr_b16 v[42:43], v5 offset:576
  ds_read_b64_tr_b16 v[44:45], v5 offset:96
  ds_read_b64_tr_b16 v[46:47], v5 offset:608
  s_waitcnt lgkmcnt(0)
  v_mfma_f32_16x16x32_bf16 v[48:51], v[24:27], v[32:35], v[48:51]
  v_mfma_f32_16x16x32_bf16 v[52:55], v[24:27], v[36:39], v[52:55]
  v_mfma_f32_16x16x32_bf16 v[56:59], v[24:27], v[40:43], v[56:59]
  v_mfma_f32_16x16x32_bf16 v[60:63], v[24:27], v[44:47], v[60:63]
  s_waitcnt vmcnt(0)
  ds_write_b128 v1, v[112:115] offset:0
  ds_write_b128 v1, v[116:119] offset:1024
  ds_write_b128 v1, v[120:123] offset:2048
  ds_write_b128 v1, v[124:127] offset:3072
  ds_read_b64_tr_b16 v[32:33], v5 offset:0
  ds_read_b64_tr_b16 v[34:35], v5 offset:512
  ds_read_b64_tr_b16 v[36:37], v5 offset:32
  ds_read_b64_tr_b16 v[38:39], v5 offset:544
  ds_read_b64_tr_b16 v[40:41], v5 offset:64
  ds_read_b64_tr_b16 v[42:43], v5 offset:576
  ds_read_b64_tr_b16 v[44:45], v5 offset:96
  ds_read_b64_tr_b16 v[46:47], v5 offset:608
  s_waitcnt lgkmcnt(0)
  v_mfma_f32_16x16x32_bf16 v[48:51], v[28:31], v[32:35], v[48:51]
  v_mfma_f32_16x16x32_bf16 v[52:55], v[28:31], v[36:39], v[52:55]
  v_mfma_f32_16x16x32_bf16 v[56:59], v[28:31], v[40:43], v[56:59]
  v_mfma_f32_16x16x32_bf16 v[60:63], v[28:31], v[44:47], v[60:63]
  s_mul_i32 s26, s27, 1664525
  s_add_u32 s26, s26, 1013904223
  s_lshl_b32 s60, s62, 1
  s_mul_i32 s60, s60, s97
  s_add_u32 s60, s60, s96
  s_lshl_b32 s64, s61, 9
  s_add_u32 s60, s60, s64
  s_add_u32 s64, s60, s97
  v_lshlrev_b32 v1, 3, v0
  v_mov_b32 v9, s26
  v_mov_b32 v11, s26
  s_nop 3
  s_mov_b32 exec_lo, 0xffff
  s_mov_b32 exec_hi, 0
  v_mov_b32 v8, v48
  v_mov_b32 v10, v49
  s_mov_b32 exec_lo, 0xffff0000
  s_mov_b32 exec_hi, 0
  v_mov_b32 v8, v52
  v_mov_b32 v10, v53
  s_mov_b32 exec_lo, 0
  s_mov_b32 exec_hi, 0xffff
  v_mov_b32 v8, v56
  v_mov_b32 v10, v57
  s_mov_b32 exec_lo, 0
  s_mov_b32 exec_hi, 0xffff0000
  v_mov_b32 v8, v60
  v_mov_b32 v10, v61
  s_mov_b64 exec, -1
  buffer_store_dwordx2 v[8:9], v1, s[36:39], s60 offen sc1
  buffer_store_dwordx2 v[10:11], v1, s[36:39], s64 offen sc1
  s_branch L_qg
L_w67:
  s_barrier
  s_waitcnt lgkmcnt(0)
  s_load_dword s27, s[24:25], 0
  s_mov_b32 s36, s24
  s_and_b32 s37, s25, 0xffff
  s_mov_b32 s38, 0x800000
  s_mov_b32 s39, 0x20000
  s_mov_b32 s44, s4
  s_and_b32 s45, s5, 0xffff
  s_mov_b32 s46, 0x800
  s_mov_b32 s47, 0x20000
  s_mov_b32 s52, s12
  s_and_b32 s53, s13, 0xffff
  s_mov_b32 s54, 0x400000
  s_mov_b32 s55, 0x20000
  s_mov_b32 s48, s20
  s_and_b32 s49, s21, 0xffff
  s_mov_b32 s50, 0x800
  s_mov_b32 s51, 0x20000
  s_cmp_eq_u32 s3, 7
  s_cbranch_scc1 L_w7
  s_branch L_qg
L_w6:
  s_mov_b32 s40, s18
  s_and_b32 s41, s19, 0xffff
  s_mov_b32 s42, 0x1c0000
  s_mov_b32 s43, 0x20000
  s_sub_u32 s60, s57, 7
  s_cmp_ge_u32 s60, 7
  s_cbranch_scc1 L_wo
  s_mul_i32 s61, s56, 7
  s_add_u32 s60, s60, s61
  s_lshr_b32 s61, s60, 2
  s_and_b32 s62, s60, 3
  v_lshrrev_b32 v2, 3, v0
  v_lshlrev_b32 v2, 10, v2
  v_and_b32 v3, 7, v0
  v_lshl_add_u32 v2, v3, 4, v2
  s_lshl_b32 s71, s61, 16
  s_lshl_b32 s63, s62, 8
  s_add_u32 s71, s71, s63
  s_add_u32 s63, s71, 0
  buffer_load_dwordx4 v[64:67], v2, s[40:43], s63 offen offset:0 nt
  s_add_u32 s63, s71, 8192
  buffer_load_dwordx4 v[68:71], v2, s[40:43], s63 offen offset:0 nt
  s_add_u32 s63, s71, 16384
  buffer_load_dwordx4 v[72:75], v2, s[40:43], s63 offen offset:0 nt
  s_add_u32 s63, s71, 24576
  buffer_load_dwordx4 v[76:79], v2, s[40:43], s63 offen offset:0 nt
  s_add_u32 s63, s71, 0
  buffer_load_dwordx4 v[80:83], v2, s[40:43], s63 offen offset:128 nt
  s_add_u32 s63, s71, 8192
  buffer_load_dwordx4 v[84:87], v2, s[40:43], s63 offen offset:128 nt
  s_add_u32 s63, s71, 16384
  buffer_load_dwordx4 v[88:91], v2, s[40:43], s63 offen offset:128 nt
  s_add_u32 s63, s71, 24576
  buffer_load_dwordx4 v[92:95], v2, s[40:43], s63 offen offset:128 nt
  s_add_u32 s63, s71, 32768
  buffer_load_dwordx4 v[96:99], v2, s[40:43], s63 offen offset:0 nt
  s_add_u32 s63, s71, 40960
  buffer_load_dwordx4 v[100:103], v2, s[40:43], s63 offen offset:0 nt
  s_add_u32 s63, s71, 49152
  buffer_load_dwordx4 v[104:107], v2, s[40:43], s63 offen offset:0 nt
  s_add_u32 s63, s71, 57344
  buffer_load_dwordx4 v[108:111], v2, s[40:43], s63 offen offset:0 nt
  s_add_u32 s63, s71, 32768
  buffer_load_dwordx4 v[112:115], v2, s[40:43], s63 offen offset:128 nt
  s_add_u32 s63, s71, 40960
  buffer_load_dwordx4 v[116:119], v2, s[40:43], s63 offen offset:128 nt
  s_add_u32 s63, s71, 49152
  buffer_load_dwordx4 v[120:123], v2, s[40:43], s63 offen offset:128 nt
  s_add_u32 s63, s71, 57344
  buffer_load_dwordx4 v[124:127], v2, s[40:43], s63 offen offset:128 nt
  v_lshlrev_b32 v1, 4, v0
  v_add_u32 v1, s65, v1
  v_lshrrev_b32 v2, 4, v0
  v_bfe_u32 v3, v0, 2, 2
  v_lshl_add_u32 v3, v2, 3, v3
  v_and_b32 v4, 3, v0
  v_lshlrev_b32 v5, 7, v3
  v_lshl_add_u32 v5, v4, 3, v5
  v_add_u32 v5, s65, v5
  s_waitcnt vmcnt(0)
  ds_write_b128 v1, v[64:67] offset:0
  ds_write_b128 v1, v[68:71] offset:1024
  ds_write_b128 v1, v[72:75] offset:2048
  ds_write_b128 v1, v[76:79] offset:3072
  ds_read_b64_tr_b16 v[128:129], v5 offset:0
  ds_read_b64_tr_b16 v[130:131], v5 offset:512
  ds_read_b64_tr_b16 v[132:133], v5 offset:32
  ds_read_b64_tr_b16 v[134:135], v5 offset:544
  ds_read_b64_tr_b16 v[136:137], v5 offset:64
  ds_read_b64_tr_b16 v[138:139], v5 offset:576
  ds_read_b64_tr_b16 v[140:141], v5 offset:96
  ds_read_b64_tr_b16 v[142:143], v5 offset:608
  s_waitcnt lgkmcnt(0)
  ds_write_b128 v1, v[80:83] offset:0
  ds_write_b128 v1, v[84:87] offset:1024
  ds_write_b128 v1, v[88:91] offset:2048
  ds_write_b128 v1, v[92:95] offset:3072
  ds_read_b64_tr_b16 v[144:145], v5 offset:0
  ds_read_b64_tr_b16 v[146:147], v5 offset:512
  ds_read_b64_tr_b16 v[148:149], v5 offset:32
  ds_read_b64_tr_b16 v[150:151], v5 offset:544
  ds_read_b64_tr_b16 v[152:153], v5 offset:64
  ds_read_b64_tr_b16 v[154:155], v5 offset:576
  ds_read_b64_tr_b16 v[156:157], v5 offset:96
  ds_read_b64_tr_b16 v[158:159], v5 offset:608
  s_waitcnt lgkmcnt(0)
  ds_write_b128 v1, v[96:99] offset:0
  ds_write_b128 v1, v[100:103] offset:1024
  ds_write_b128 v1, v[104:107] offset:2048
  ds_write_b128 v1, v[108:111] offset:3072
  ds_read_b64_tr_b16 v[160:161], v5 offset:0
  ds_read_b64_tr_b16 v[162:163], v5 offset:512
  ds_read_b64_tr_b16 v[164:165], v5 offset:32
  ds_read_b64_tr_b16 v[166:167], v5 offset:544
  ds_read_b64_tr_b16 v[168:169], v5 offset:64
  ds_read_b64_tr_b16 v[170:171], v5 offset:576
  ds_read_b64_tr_b16 v[172:173], v5 offset:96
  ds_read_b64_tr_b16 v[174:175], v5 offset:608
  s_waitcnt lgkmcnt(0)
  ds_write_b128 v1, v[112:115] offset:0
  ds_write_b128 v1, v[116:119] offset:1024
  ds_write_b128 v1, v[120:123] offset:2048
  ds_write_b128 v1, v[124:127] offset:3072
  ds_read_b64_tr_b16 v[176:177], v5 offset:0
  ds_read_b64_tr_b16 v[178:179], v5 offset:512
  ds_read_b64_tr_b16 v[180:181], v5 offset:32
  ds_read_b64_tr_b16 v[182:183], v5 offset:544
  ds_read_b64_tr_b16 v[184:185], v5 offset:64
  ds_read_b64_tr_b16 v[186:187], v5 offset:576
  ds_read_b64_tr_b16 v[188:189], v5 offset:96
  ds_read_b64_tr_b16 v[190:191], v5 offset:608
  s_waitcnt lgkmcnt(0)
  v_lshrrev_b32 v6, 5, v0
  v_mul_u32_u24 v6, 14336, v6
  v_and_b32 v7, 31, v0
  v_lshl_add_u32 v6, v7, 4, v6
  s_lshl_b32 s60, s61, 9
  s_add_u32 s60, s60, 2359296
  s_mov_b32 s66, 0x40000
L_poll_h_5:
  s_add_u32 s63, s60, 0
  buffer_load_dwordx4 v[16:19], v6, s[36:39], s63 offen sc1
  s_add_u32 s63, s60, 28672
  buffer_load_dwordx4 v[20:23], v6, s[36:39], s63 offen sc1
  s_add_u32 s63, s60, 57344
  buffer_load_dwordx4 v[24:27], v6, s[36:39], s63 offen sc1
  s_add_u32 s63, s60, 86016
  buffer_load_dwordx4 v[28:31], v6, s[36:39], s63 offen sc1
  s_waitcnt vmcnt(0)
  v_xor_b32 v8, s26, v17
  v_xor_b32 v9, s26, v19
  v_or_b32 v8, v8, v9
  v_xor_b32 v9, s26, v21
  v_or_b32 v8, v8, v9
  v_xor_b32 v9, s26, v23
  v_or_b32 v8, v8, v9
  v_xor_b32 v9, s26, v25
  v_or_b32 v8, v8, v9
  v_xor_b32 v9, s26, v27
  v_or_b32 v8, v8, v9
  v_xor_b32 v9, s26, v29
  v_or_b32 v8, v8, v9
  v_xor_b32 v9, s26, v31
  v_or_b32 v8, v8, v9
  v_cmp_ne_u32 vcc, 0, v8
  s_cbranch_vccz L_polld_h_6
  s_mov_b64 exec, vcc
  s_sub_u32 s66, s66, 1
  s_cbranch_scc1 L_pollto_h_7
  s_sleep 8
  s_branch L_poll_h_5
L_pollto_h_7:
  v_mov_b32 v8, 4
  v_mov_b32 v9, s2
  v_add_u32 v9, 0x1000, v9
  global_store_dword v8, v9, s[22:23]
L_polld_h_6:
  s_mov_b64 exec, -1
  v_add_f32 v16, v16, v20
  v_add_f32 v18, v18, v22
  v_add_f32 v24, v24, v28
  v_add_f32 v26, v26, v30
  v_add_f32 v16, v16, v24
  v_add_f32 v18, v18, v26
  v_cvt_pk_bf16_f32 v8, v16, v18
  v_lshlrev_b32 v10, 16, v8
  v_and_b32 v11, 0xffff0000, v8
  s_mov_b32 s60, 0x3fb8aa3b
  v_mul_f32 v12, s60, v10
  v_exp_f32 v12, -v12
  s_nop 0
  v_add_f32 v12, 1.0, v12
  v_rcp_f32 v12, v12
  s_nop 0
  v_mul_f32 v10, v10, v12
  v_mul_f32 v12, s60, v11
  v_exp_f32 v12, -v12
  s_nop 0
  v_add_f32 v12, 1.0, v12
  v_rcp_f32 v12, v12
  s_nop 0
  v_mul_f32 v11, v11, v12
  v_cvt_pk_bf16_f32 v12, v10, v11
  v_lshlrev_b32 v7, 2, v0
  v_add_u32 v7, 152576, v7
  ds_write_b32 v7, v12
  v_and_b32 v6, 1, v0
  v_lshlrev_b32 v6, 7, v6
  v_lshl_add_u32 v6, v2, 4, v6
  v_add_u32 v6, 152576, v6
  ds_read_b128 v[16:19], v6
  ds_read_b128 v[20:23], v6 offset:64
  s_waitcnt lgkmcnt(0)
  v_mfma_f32_16x16x32_bf16 v[64:67], v[16:19], v[128:131], 0
  v_mfma_f32_16x16x32_bf16 v[68:71], v[16:19], v[132:135], 0
  v_mfma_f32_16x16x32_bf16 v[72:75], v[16:19], v[136:139], 0
  v_mfma_f32_16x16x32_bf16 v[76:79], v[16:19], v[140:143], 0
  v_mfma_f32_16x16x32_bf16 v[80:83], v[16:19], v[144:147], 0
  v_mfma_f32_16x16x32_bf16 v[84:87], v[16:19], v[148:151], 0
  v_mfma_f32_16x16x32_bf16 v[88:91], v[16:19], v[152:155], 0
  v_mfma_f32_16x16x32_bf16 v[92:95], v[16:19], v[156:159], 0
  v_mfma_f32_16x16x32_bf16 v[64:67], v[20:23], v[160:163], v[64:67]
  v_mfma_f32_16x16x32_bf16 v[68:71], v[20:23], v[164:167], v[68:71]
  v_mfma_f32_16x16x32_bf16 v[72:75], v[20:23], v[168:171], v[72:75]
  v_mfma_f32_16x16x32_bf16 v[76:79], v[20:23], v[172:175], v[76:79]
  v_mfma_f32_16x16x32_bf16 v[80:83], v[20:23], v[176:179], v[80:83]
  v_mfma_f32_16x16x32_bf16 v[84:87], v[20:23], v[180:183], v[84:87]
  v_mfma_f32_16x16x32_bf16 v[88:91], v[20:23], v[184:187], v[88:91]
  v_mfma_f32_16x16x32_bf16 v[92:95], v[20:23], v[188:191], v[92:95]
  s_nop 9
  v_and_b32 v1, 15, v0
  v_lshlrev_b32 v1, 3, v1
  s_lshl_b32 s60, s61, 13
  s_lshl_b32 s63, s62, 10
  s_add_u32 s60, s60, s63
  s_add_u32 s60, s60, 196608
  s_add_u32 s63, s60, 4096
  v_mov_b32 v9, s26
  v_mov_b32 v11, s26
  s_mov_b64 exec, 0xffff
  v_mov_b32 v8, v64
  v_mov_b32 v10, v65
  buffer_store_dwordx2 v[8:9], v1, s[36:39], s60 offen offset:0 sc1
  buffer_store_dwordx2 v[10:11], v1, s[36:39], s63 offen offset:0 sc1
  s_nop 1
  v_mov_b32 v8, v68
  v_mov_b32 v10, v69
  buffer_store_dwordx2 v[8:9], v1, s[36:39], s60 offen offset:128 sc1
  buffer_store_dwordx2 v[10:11], v1, s[36:39], s63 offen offset:128 sc1
  s_nop 1
  v_mov_b32 v8, v72
  v_mov_b32 v10, v73
  buffer_store_dwordx2 v[8:9], v1, s[36:39], s60 offen offset:256 sc1
  buffer_store_dwordx2 v[10:11], v1, s[36:39], s63 offen offset:256 sc1
  s_nop 1
  v_mov_b32 v8, v76
  v_mov_b32 v10, v77
  buffer_store_dwordx2 v[8:9], v1, s[36:39], s60 offen offset:384 sc1
  buffer_store_dwordx2 v[10:11], v1, s[36:39], s63 offen offset:384 sc1
  s_nop 1
  v_mov_b32 v8, v80
  v_mov_b32 v10, v81
  buffer_store_dwordx2 v[8:9], v1, s[36:39], s60 offen offset:512 sc1
  buffer_store_dwordx2 v[10:11], v1, s[36:39], s63 offen offset:512 sc1
  s_nop 1
  v_mov_b32 v8, v84
  v_mov_b32 v10, v85
  buffer_store_dwordx2 v[8:9], v1, s[36:39], s60 offen offset:640 sc1
  buffer_store_dwordx2 v[10:11], v1, s[36:39], s63 offen offset:640 sc1
  s_nop 1
  v_mov_b32 v8, v88
  v_mov_b32 v10, v89
  buffer_store_dwordx2 v[8:9], v1, s[36:39], s60 offen offset:768 sc1
  buffer_store_dwordx2 v[10:11], v1, s[36:39], s63 offen offset:768 sc1
  s_nop 1
  v_mov_b32 v8, v92
  v_mov_b32 v10, v93
  buffer_store_dwordx2 v[8:9], v1, s[36:39], s60 offen offset:896 sc1
  buffer_store_dwordx2 v[10:11], v1, s[36:39], s63 offen offset:896 sc1
  s_nop 1
  s_mov_b64 exec, -1
  s_branch L_wo
L_w7:
  s_lshr_b32 s60, s2, 3
  s_and_b32 s60, s60, 7
  s_cmp_lg_u32 s60, 0
  s_cbranch_scc1 L_qg
  s_getpc_b64 s[60:61]
L_pcbase:
  s_sub_u32 s60, s60, L_pcbase-recurrent_scan__gqa_block_cached__dense_activation_silu__decode_kernel
  s_subb_u32 s61, s61, 0
  v_lshlrev_b32 v1, 7, v0
  v_min_u32 v3, L_code_end-recurrent_scan__gqa_block_cached__dense_activation_silu__decode_kernel-4, v1
  global_load_dword v230, v3, s[60:61]
  v_add_u32 v1, 8192, v1
  v_min_u32 v3, L_code_end-recurrent_scan__gqa_block_cached__dense_activation_silu__decode_kernel-4, v1
  global_load_dword v230, v3, s[60:61]
  v_add_u32 v1, 8192, v1
  v_min_u32 v3, L_code_end-recurrent_scan__gqa_block_cached__dense_activation_silu__decode_kernel-4, v1
  global_load_dword v230, v3, s[60:61]
  v_add_u32 v1, 8192, v1
  s_branch L_qg
L_hb0:
  s_barrier
  s_load_dword s27, s[24:25], 0
  s_mov_b32 s36, s24
  s_and_b32 s37, s25, 0xffff
  s_mov_b32 s38, 0x800000
  s_mov_b32 s39, 0x20000
  s_mov_b32 s44, s4
  s_and_b32 s45, s5, 0xffff
  s_mov_b32 s46, 0x800
  s_mov_b32 s47, 0x20000
  s_mov_b32 s52, s12
  s_and_b32 s53, s13, 0xffff
  s_mov_b32 s54, 0x400000
  s_mov_b32 s55, 0x20000
  s_mov_b32 s48, s20
  s_and_b32 s49, s21, 0xffff
  s_mov_b32 s50, 0x800
  s_mov_b32 s51, 0x20000
L_qg:
  s_waitcnt lgkmcnt(0)
  s_mul_i32 s26, s27, 1664525
  s_add_u32 s26, s26, 1013904223
  s_lshl_b32 s60, s58, 12
  s_lshl_b32 s62, s59, 9
  s_add_u32 s60, s60, s62
  s_sub_u32 s62, s3, 4
  s_lshl_b32 s61, s62, 7
  s_add_u32 s60, s60, s61
  s_lshl_b32 s60, s60, 3
  s_add_u32 s60, s60, 2097152
  v_mov_b32 v2, 153856
  s_cmp_lg_u32 s3, 4
  s_cbranch_scc1 L_qfw_8
  v_mov_b32 v3, s26
  ds_write_b32 v2, v3
  s_branch L_qfg_9
L_qfw_8:
  s_mov_b32 s66, 0x100000
L_qfw2_10:
  ds_read_b32 v3, v2
  s_waitcnt lgkmcnt(0)
  v_readfirstlane_b32 s61, v3
  s_cmp_eq_u32 s61, s26
  s_cbranch_scc1 L_qfg_9
  s_sub_u32 s66, s66, 1
  s_cbranch_scc1 L_qfg_9
  s_sleep 2
  s_branch L_qfw2_10
L_qfg_9:
  v_lshlrev_b32 v1, 4, v0
  s_mov_b32 s66, 0x40000
L_poll_q_11:
  s_add_u32 s61, s60, 0
  buffer_load_dwordx4 v[16:19], v1, s[36:39], s61 offen sc1
  s_add_u32 s61, s60, 65536
  buffer_load_dwordx4 v[20:23], v1, s[36:39], s61 offen sc1
  s_add_u32 s61, s60, 131072
  buffer_load_dwordx4 v[24:27], v1, s[36:39], s61 offen sc1
  s_add_u32 s61, s60, 196608
  buffer_load_dwordx4 v[28:31], v1, s[36:39], s61 offen sc1
  s_waitcnt vmcnt(0)
  v_xor_b32 v8, s26, v17
  v_xor_b32 v9, s26, v19
  v_or_b32 v8, v8, v9
  v_xor_b32 v9, s26, v21
  v_or_b32 v8, v8, v9
  v_xor_b32 v9, s26, v23
  v_or_b32 v8, v8, v9
  v_xor_b32 v9, s26, v25
  v_or_b32 v8, v8, v9
  v_xor_b32 v9, s26, v27
  v_or_b32 v8, v8, v9
  v_xor_b32 v9, s26, v29
  v_or_b32 v8, v8, v9
  v_xor_b32 v9, s26, v31
  v_or_b32 v8, v8, v9
  v_cmp_ne_u32 vcc, 0, v8
  s_cbranch_vccz L_polld_q_12
  s_mov_b64 exec, vcc
  s_sub_u32 s66, s66, 1
  s_cbranch_scc1 L_pollto_q_13
  s_sleep 4
  s_branch L_poll_q_11
L_pollto_q_13:
  v_mov_b32 v8, 0
  v_mov_b32 v9, s2
  v_add_u32 v9, 0x1000, v9
  global_store_dword v8, v9, s[22:23]
L_polld_q_12:
  s_mov_b64 exec, -1
  v_add_f32 v16, v16, v20
  v_add_f32 v18, v18, v22
  v_add_f32 v24, v24, v28
  v_add_f32 v26, v26, v30
  v_add_f32 v16, v16, v24
  v_add_f32 v18, v18, v26
  v_cvt_pk_bf16_f32 v12, v16, v18
  s_lshl_b32 s62, s62, 8
  s_add_u32 s62, s62, 151552
  v_lshlrev_b32 v1, 2, v0
  v_add_u32 v1, s62, v1
  ds_write_b32 v1, v12
  s_waitcnt lgkmcnt(0)
  s_barrier
  s_cmp_eq_u32 s3, 6
  s_cbranch_scc1 L_w6
L_wo:
  s_and_b32 s60, s57, 3
  s_lshl_b32 s61, s59, 2
  s_add_u32 s61, s61, s60
  s_lshl_b32 s71, s61, 17
  s_bfe_u32 s62, s57, 0x10002
  s_lshl_b32 s62, s62, 16
  s_add_u32 s71, s71, s62
  s_lshr_b32 s62, s57, 3
  s_lshl_b32 s62, s62, 9
  s_add_u32 s71, s71, s62
  s_sub_u32 s62, s3, 4
  s_lshl_b32 s62, s62, 7
  s_add_u32 s71, s71, s62
  v_lshrrev_b32 v2, 3, v0
  v_lshlrev_b32 v2, 10, v2
  v_and_b32 v3, 7, v0
  v_lshl_add_u32 v2, v3, 4, v2
  buffer_load_dwordx4 v[64:67], v2, s[52:55], s71 offen
  s_add_u32 s71, s71, 8192
  buffer_load_dwordx4 v[68:71], v2, s[52:55], s71 offen
  s_add_u32 s71, s71, 8192
  buffer_load_dwordx4 v[72:75], v2, s[52:55], s71 offen
  s_add_u32 s71, s71, 8192
  buffer_load_dwordx4 v[76:79], v2, s[52:55], s71 offen
  s_add_u32 s71, s71, 8192
  buffer_load_dwordx4 v[80:83], v2, s[52:55], s71 offen
  s_add_u32 s71, s71, 8192
  buffer_load_dwordx4 v[84:87], v2, s[52:55], s71 offen
  s_add_u32 s71, s71, 8192
  buffer_load_dwordx4 v[88:91], v2, s[52:55], s71 offen
  s_add_u32 s71, s71, 8192
  buffer_load_dwordx4 v[92:95], v2, s[52:55], s71 offen
  v_lshlrev_b32 v1, 4, v0
  v_add_u32 v1, s65, v1
  v_lshrrev_b32 v2, 4, v0
  v_bfe_u32 v3, v0, 2, 2
  v_lshl_add_u32 v3, v2, 3, v3
  v_and_b32 v4, 3, v0
  v_lshlrev_b32 v5, 7, v3
  v_lshl_add_u32 v5, v4, 3, v5
  v_add_u32 v5, s65, v5
  s_waitcnt vmcnt(0)
  ds_write_b128 v1, v[64:67] offset:0
  ds_write_b128 v1, v[68:71] offset:1024
  ds_write_b128 v1, v[72:75] offset:2048
  ds_write_b128 v1, v[76:79] offset:3072
  ds_read_b64_tr_b16 v[192:193], v5 offset:0
  ds_read_b64_tr_b16 v[194:195], v5 offset:512
  ds_read_b64_tr_b16 v[196:197], v5 offset:32
  ds_read_b64_tr_b16 v[198:199], v5 offset:544
  ds_read_b64_tr_b16 v[200:201], v5 offset:64
  ds_read_b64_tr_b16 v[202:203], v5 offset:576
  ds_read_b64_tr_b16 v[204:205], v5 offset:96
  ds_read_b64_tr_b16 v[206:207], v5 offset:608
  s_waitcnt lgkmcnt(0)
  ds_write_b128 v1, v[80:83] offset:0
  ds_write_b128 v1, v[84:87] offset:1024
  ds_write_b128 v1, v[88:91] offset:2048
  ds_write_b128 v1, v[92:95] offset:3072
  ds_read_b64_tr_b16 v[208:209], v5 offset:0
  ds_read_b64_tr_b16 v[210:211], v5 offset:512
  ds_read_b64_tr_b16 v[212:213], v5 offset:32
  ds_read_b64_tr_b16 v[214:215], v5 offset:544
  ds_read_b64_tr_b16 v[216:217], v5 offset:64
  ds_read_b64_tr_b16 v[218:219], v5 offset:576
  ds_read_b64_tr_b16 v[220:221], v5 offset:96
  ds_read_b64_tr_b16 v[222:223], v5 offset:608
  s_waitcnt lgkmcnt(0)
L_wodone:
  s_cmp_lg_u32 s3, 7
  s_cbranch_scc1 L_hb2
  s_xor_b32 s60, s57, s56
  s_and_b32 s60, s60, 3
  s_cmp_lg_u32 s60, 0
  s_cbranch_scc1 L_hb2
  s_lshr_b32 s68, s57, 2
  s_and_b32 s60, s68, 1
  s_lshl_b32 s60, s60, 1
  s_lshr_b32 s68, s68, 1
  s_add_u32 s68, s68, s60
  s_lshl_b32 s60, s56, 2
  s_add_u32 s68, s68, s60
  v_lshrrev_b32 v2, 5, v0
  v_bfe_u32 v3, v0, 2, 3
  v_and_b32 v4, 3, v0
  v_min_u32 v7, 6, v3
  v_mul_u32_u24 v5, 32768, v7
  v_lshl_add_u32 v5, v2, 12, v5
  v_lshl_add_u32 v5, v4, 4, v5
  s_lshl_b32 s60, s68, 6
  v_add_u32 v5, s60, v5
  v_lshlrev_b32 v6, 10, v2
  v_lshl_add_u32 v6, v4, 2, v6
  s_lshl_b32 s61, s68, 4
  v_add_u32 v6, s61, v6
  buffer_load_dword v226, v6, s[44:47], 0 offen
  s_mov_b32 s66, 0x40000
L_poll_f_14:
  s_mov_b32 s61, 196608
  buffer_load_dwordx4 v[16:19], v5, s[36:39], s61 offen sc1
  s_mov_b32 s61, 204800
  buffer_load_dwordx4 v[20:23], v5, s[36:39], s61 offen sc1
  s_mov_b32 s61, 212992
  buffer_load_dwordx4 v[24:27], v5, s[36:39], s61 offen sc1
  s_mov_b32 s61, 221184
  buffer_load_dwordx4 v[28:31], v5, s[36:39], s61 offen sc1
  s_waitcnt vmcnt(0)
  v_xor_b32 v8, s26, v17
  v_xor_b32 v9, s26, v19
  v_or_b32 v8, v8, v9
  v_xor_b32 v9, s26, v21
  v_or_b32 v8, v8, v9
  v_xor_b32 v9, s26, v23
  v_or_b32 v8, v8, v9
  v_xor_b32 v9, s26, v25
  v_or_b32 v8, v8, v9
  v_xor_b32 v9, s26, v27
  v_or_b32 v8, v8, v9
  v_xor_b32 v9, s26, v29
  v_or_b32 v8, v8, v9
  v_xor_b32 v9, s26, v31
  v_or_b32 v8, v8, v9
  v_cmp_ne_u32 vcc, 0, v8
  s_cbranch_vccz L_polld_f_15
  s_mov_b64 exec, vcc
  s_sub_u32 s66, s66, 1
  s_cbranch_scc1 L_pollto_f_16
  s_sleep 16
  s_branch L_poll_f_14
L_pollto_f_16:
  v_mov_b32 v8, 8
  v_mov_b32 v9, s2
  v_add_u32 v9, 0x1000, v9
  global_store_dword v8, v9, s[22:23]
L_polld_f_15:
  s_mov_b64 exec, -1
  v_add_f32 v16, v16, v20
  v_add_f32 v18, v18, v22
  v_add_f32 v24, v24, v28
  v_add_f32 v26, v26, v30
  v_add_f32 v16, v16, v24
  v_add_f32 v18, v18, v26
  v_cmp_gt_u32 vcc, 7, v3
  s_nop 1
  v_cndmask_b32 v16, 0, v16, vcc
  v_cndmask_b32 v18, 0, v18, vcc
  s_nop 1
  v_add_f32_dpp v16, v16, v16 row_ror:4 row_mask:0xf bank_mask:0xf
  v_add_f32_dpp v18, v18, v18 row_ror:4 row_mask:0xf bank_mask:0xf
  s_nop 1
  v_add_f32_dpp v16, v16, v16 row_ror:8 row_mask:0xf bank_mask:0xf
  v_add_f32_dpp v18, v18, v18 row_ror:8 row_mask:0xf bank_mask:0xf
  s_nop 0
  v_mov_b32 v20, v16
  v_mov_b32 v21, v18
  s_nop 1
  v_permlane16_swap_b32 v16, v20
  v_permlane16_swap_b32 v18, v21
  s_nop 0
  v_add_f32 v16, v16, v20
  v_add_f32 v18, v18, v21
  v_cvt_pk_bf16_f32 v8, v16, v18
  v_lshlrev_b32 v10, 16, v8
  v_and_b32 v11, 0xffff0000, v8
  s_mov_b32 s60, 0x3fb8aa3b
  v_mul_f32 v12, s60, v10
  v_exp_f32 v12, -v12
  s_nop 0
  v_add_f32 v12, 1.0, v12
  v_rcp_f32 v12, v12
  s_nop 0
  v_mul_f32 v10, v10, v12
  v_mul_f32 v12, s60, v11
  v_exp_f32 v12, -v12
  s_nop 0
  v_add_f32 v12, 1.0, v12
  v_rcp_f32 v12, v12
  s_nop 0
  v_mul_f32 v11, v11, v12
  v_cvt_pk_bf16_f32 v8, v10, v11
  v_lshlrev_b32 v224, 16, v8
  v_and_b32 v225, 0xffff0000, v8
L_hb2:
  s_sub_u32 s60, s3, 4
  s_lshl_b32 s61, s60, 9
  v_lshlrev_b32 v232, 2, v0
  v_add_u32 v232, s61, v232
  v_add_u32 v233, 65536, v232
  s_lshl_b32 s61, s60, 3
  s_add_u32 s61, s61, 153600
  v_mov_b32 v234, s61
  v_lshlrev_b32 v235, 4, v0
  v_and_b32 v228, 1, v0
  s_lshl_b32 s67, s56, 4
  s_add_u32 s67, s67, s57
  s_lshl_b32 s67, s67, 2
  s_add_u32 s67, s67, s60
  s_lshl_b32 s67, s67, 11
  s_add_u32 s67, s67, 4194304
  v_lshrrev_b32 v236, 4, v0
  v_lshlrev_b32 v236, 4, v236
  v_add_u32 v236, 153088, v236
  v_lshlrev_b32 v237, 3, v0
  s_and_b32 s62, s57, 3
  s_lshl_b32 s69, s59, 2
  s_add_u32 s69, s69, s62
  s_lshl_b32 s69, s69, 1
  s_bfe_u32 s62, s57, 0x10002
  s_add_u32 s69, s69, s62
  s_lshl_b32 s62, s58, 6
  s_add_u32 s69, s69, s62
  s_lshl_b32 s69, s69, 12
  s_lshr_b32 s62, s57, 3
  s_lshl_b32 s62, s62, 11
  s_add_u32 s69, s69, s62
  s_lshl_b32 s62, s60, 9
  s_add_u32 s69, s69, s62
  s_add_u32 s69, s69, 524288
  s_lshr_b32 s68, s57, 2
  s_and_b32 s61, s68, 1
  s_lshl_b32 s61, s61, 1
  s_lshr_b32 s68, s68, 1
  s_add_u32 s68, s68, s61
  s_lshl_b32 s61, s56, 2
  s_add_u32 s68, s68, s61
  v_lshrrev_b32 v2, 5, v0
  v_bfe_u32 v3, v0, 2, 3
  v_and_b32 v4, 3, v0
  v_lshlrev_b32 v238, 18, v2
  v_lshl_add_u32 v238, v3, 15, v238
  v_lshl_add_u32 v238, v4, 4, v238
  s_lshl_b32 s60, s68, 6
  v_add_u32 v238, s60, v238
  v_lshlrev_b32 v239, 10, v2
  v_lshl_add_u32 v239, v4, 2, v239
  s_lshl_b32 s61, s68, 4
  v_add_u32 v239, s61, v239
  s_mov_b32 s70, 0xffff0000
  s_mov_b32 s71, 0
  s_mov_b32 s72, 0
  s_mov_b32 s73, 0x0000ffff
  s_mov_b32 s74, 0
  s_mov_b32 s75, 0xffff0000
  v_mov_b32 v41, s26
  v_mov_b32 v43, s26
  v_mov_b32 v45, s26
  v_mov_b32 v47, s26
  s_mov_b32 s96, 0x3fb8aa3b
  s_getpc_b64 s[62:63]
L_pc2:
  s_add_u32 s62, s62, L_tail-L_pc2
  s_addc_u32 s63, s63, 0
  v_lshlrev_b32 v229, 7, v0
  v_min_u32 v229, L_code_end-L_tail-4, v229
L_tail:
  s_barrier
  s_cmp_lt_u32 s3, 4
  s_cbranch_scc1 L_t2
  ds_read_b32 v8, v232
  ds_read_b32 v9, v232 offset:256
  ds_read_b32 v10, v232 offset:32768
  ds_read_b32 v11, v232 offset:33024
  ds_read_b32 v12, v233
  ds_read_b32 v13, v233 offset:256
  ds_read_b32 v14, v233 offset:32768
  ds_read_b32 v15, v233 offset:33024
  ds_read_b64 v[16:17], v234 offset:0
  ds_read_b64 v[18:19], v234 offset:32
  ds_read_b64 v[20:21], v234 offset:64
  ds_read_b64 v[22:23], v234 offset:96
  s_cmp_lg_u32 s3, 7
  s_cbranch_scc1 L_tpf_17
  s_mov_b32 exec_hi, 0
  global_load_dword v230, v229, s[62:63]
  s_mov_b64 exec, -1
L_tpf_17:
  v_cmp_eq_u32 vcc, 1, v228
  s_waitcnt lgkmcnt(0)
  v_max3_f32 v24, v16, v18, v20
  v_max_f32 v24, v24, v22
  v_sub_f32 v16, v16, v24
  v_sub_f32 v18, v18, v24
  v_sub_f32 v20, v20, v24
  v_sub_f32 v22, v22, v24
  v_mul_f32 v16, s96, v16
  v_mul_f32 v18, s96, v18
  v_mul_f32 v20, s96, v20
  v_mul_f32 v22, s96, v22
  v_exp_f32 v16, v16
  v_exp_f32 v18, v18
  v_exp_f32 v20, v20
  v_exp_f32 v22, v22
  s_nop 0
  v_mul_f32 v40, v8, v16
  v_mul_f32 v44, v9, v16
  v_mul_f32 v46, v17, v16
  v_fmac_f32 v40, v10, v18
  v_fmac_f32 v44, v11, v18
  v_fmac_f32 v46, v19, v18
  v_fmac_f32 v40, v12, v20
  v_fmac_f32 v44, v13, v20
  v_fmac_f32 v46, v21, v20
  v_fmac_f32 v40, v14, v22
  v_fmac_f32 v44, v15, v22
  v_fmac_f32 v46, v23, v22
  v_cndmask_b32 v42, v24, v46, vcc
  v_mov_b32 v46, v42
  buffer_store_dwordx4 v[40:43], v235, s[36:39], s67 offen sc1
  buffer_store_dwordx4 v[44:47], v235, s[36:39], s67 offen offset:1024 sc1
L_t2:
  s_and_b32 s60, s57, 3
  v_lshrrev_b32 v2, 2, v0
  v_and_b32 v3, 3, v0
  v_lshlrev_b32 v5, 13, v2
  v_lshl_add_u32 v4, v3, 5, v5
  s_lshl_b32 s61, s56, 17
  s_lshl_b32 s62, s60, 11
  s_add_u32 s61, s61, s62
  s_bfe_u32 s62, s57, 0x10002
  s_lshl_b32 s62, s62, 10
  s_add_u32 s61, s61, s62
  s_lshl_b32 s62, s3, 7
  s_add_u32 s61, s61, s62
  s_add_u32 s61, s61, 4194304
  s_cmp_eq_u32 s3, 0
  s_cbranch_scc1 L_gate_18
  s_barrier
L_gate_18:
  s_mov_b32 s66, 0x40000
L_poll_p_19:
  buffer_load_dwordx4 v[8:11], v4, s[36:39], s61 offen sc1
  buffer_load_dwordx4 v[12:15], v4, s[36:39], s61 offen offset:16 sc1
  s_waitcnt vmcnt(0)
  v_xor_b32 v24, s26, v9
  v_xor_b32 v25, s26, v11
  v_or_b32 v24, v24, v25
  v_xor_b32 v25, s26, v13
  v_or_b32 v24, v24, v25
  v_xor_b32 v25, s26, v15
  v_or_b32 v24, v24, v25
  v_cmp_ne_u32 vcc, 0, v24
  s_cbranch_vccz L_polld_p_20
  s_mov_b64 exec, vcc
  s_sub_u32 s66, s66, 1
  s_cbranch_scc1 L_pollto_p_21
  s_sleep 1
  s_branch L_poll_p_19
L_pollto_p_21:
  v_mov_b32 v24, 12
  v_mov_b32 v25, s2
  v_add_u32 v25, 0x1000, v25
  global_store_dword v24, v25, s[22:23]
L_polld_p_20:
  s_mov_b64 exec, -1
  s_cmp_lg_u32 s3, 0
  s_cbranch_scc1 L_gate2_22
  s_barrier
L_gate2_22:
  v_mov_b32 v16, v10
  v_mov_b32 v18, v14
  v_mov_b32 v10, v12
  v_mov_b32 v20, v16
  s_nop 1
  v_max_f32_dpp v20, v20, v20 row_ror:4 row_mask:0xf bank_mask:0xf
  s_nop 1
  v_max_f32_dpp v20, v20, v20 row_ror:8 row_mask:0xf bank_mask:0xf
  s_nop 0
  v_mov_b32 v21, v20
  s_nop 1
  v_permlane16_swap_b32 v20, v21
  s_nop 0
  v_max_f32 v20, v20, v21
  v_mov_b32 v21, v20
  s_nop 1
  v_permlane32_swap_b32 v20, v21
  s_nop 0
  v_max_f32 v20, v20, v21
  s_mov_b32 s96, 0x3fb8aa3b
  v_sub_f32 v16, v16, v20
  v_mul_f32 v16, s96, v16
  v_exp_f32 v16, v16
  s_nop 0
  v_mul_f32 v18, v18, v16
  v_mul_f32 v8, v8, v16
  v_mul_f32 v10, v10, v16
  s_nop 1
  v_add_f32_dpp v8, v8, v8 row_ror:4 row_mask:0xf bank_mask:0xf
  v_add_f32_dpp v10, v10, v10 row_ror:4 row_mask:0xf bank_mask:0xf
  v_add_f32_dpp v18, v18, v18 row_ror:4 row_mask:0xf bank_mask:0xf
  s_nop 1
  v_add_f32_dpp v8, v8, v8 row_ror:8 row_mask:0xf bank_mask:0xf
  v_add_f32_dpp v10, v10, v10 row_ror:8 row_mask:0xf bank_mask:0xf
  v_add_f32_dpp v18, v18, v18 row_ror:8 row_mask:0xf bank_mask:0xf
  s_nop 0
  v_mov_b32 v26, v8
  v_mov_b32 v27, v10
  v_mov_b32 v28, v18
  s_nop 0
  v_permlane16_swap_b32 v8, v26
  v_permlane16_swap_b32 v10, v27
  v_permlane16_swap_b32 v18, v28
  s_nop 0
  v_add_f32 v8, v8, v26
  v_add_f32 v10, v10, v27
  v_add_f32 v18, v18, v28
  s_nop 0
  v_mov_b32 v26, v8
  v_mov_b32 v27, v10
  v_mov_b32 v28, v18
  s_nop 0
  v_permlane32_swap_b32 v8, v26
  v_permlane32_swap_b32 v10, v27
  v_permlane32_swap_b32 v18, v28
  s_nop 0
  v_add_f32 v8, v8, v26
  v_add_f32 v10, v10, v27
  v_add_f32 v18, v18, v28
  s_nop 0
  v_rcp_f32 v19, v18
  s_nop 0
  v_mul_f32 v20, v8, v19
  v_fma_f32 v21, -v20, v18, v8
  v_fma_f32 v8, v21, v19, v20
  v_mul_f32 v20, v10, v19
  v_fma_f32 v21, -v20, v18, v10
  v_fma_f32 v10, v21, v19, v20
  v_cvt_pk_bf16_f32 v22, v8, v10
  s_lshl_b32 s62, s3, 4
  s_add_u32 s62, s62, 153088
  v_lshlrev_b32 v3, 2, v3
  v_add_u32 v3, s62, v3
  s_mov_b64 exec, 0xf
  ds_write_b32 v3, v22
  s_mov_b64 exec, -1
  s_waitcnt lgkmcnt(0)
  s_barrier
  s_cmp_lt_u32 s3, 4
  s_cbranch_scc1 L_fin
  ds_read_b128 v[8:11], v236 offset:0
  ds_read_b128 v[12:15], v236 offset:64
  s_waitcnt lgkmcnt(0)
  v_mfma_f32_16x16x32_bf16 v[16:19], v[8:11], v[192:195], 0
  v_mfma_f32_16x16x32_bf16 v[20:23], v[8:11], v[196:199], 0
  v_mfma_f32_16x16x32_bf16 v[24:27], v[8:11], v[200:203], 0
  v_mfma_f32_16x16x32_bf16 v[28:31], v[8:11], v[204:207], 0
  v_mfma_f32_16x16x32_bf16 v[16:19], v[12:15], v[208:211], v[16:19]
  v_mfma_f32_16x16x32_bf16 v[20:23], v[12:15], v[212:215], v[20:23]
  v_mfma_f32_16x16x32_bf16 v[24:27], v[12:15], v[216:219], v[24:27]
  v_mfma_f32_16x16x32_bf16 v[28:31], v[12:15], v[220:223], v[28:31]
  s_nop 5
  v_cndmask_b32 v40, v16, v20, s[70:71]
  v_cndmask_b32 v40, v40, v24, s[72:73]
  s_nop 0
  v_cndmask_b32 v40, v40, v28, s[74:75]
  buffer_store_dwordx2 v[40:41], v237, s[36:39], s69 offen sc1
  s_cmp_lg_u32 s3, 7
  s_cbranch_scc1 L_fin
  s_xor_b32 s60, s57, s56
  s_and_b32 s60, s60, 3
  s_cmp_lg_u32 s60, 0
  s_cbranch_scc1 L_fin
  s_mov_b32 s66, 0x40000
L_poll_s_23:
  s_mov_b32 s61, 524288
  buffer_load_dwordx4 v[64:67], v238, s[36:39], s61 offen sc1
  s_mov_b32 s61, 528384
  buffer_load_dwordx4 v[68:71], v238, s[36:39], s61 offen sc1
  s_mov_b32 s61, 532480
  buffer_load_dwordx4 v[72:75], v238, s[36:39], s61 offen sc1
  s_mov_b32 s61, 536576
  buffer_load_dwordx4 v[76:79], v238, s[36:39], s61 offen sc1
  s_mov_b32 s61, 540672
  buffer_load_dwordx4 v[80:83], v238, s[36:39], s61 offen sc1
  s_mov_b32 s61, 544768
  buffer_load_dwordx4 v[84:87], v238, s[36:39], s61 offen sc1
  s_mov_b32 s61, 548864
  buffer_load_dwordx4 v[88:91], v238, s[36:39], s61 offen sc1
  s_mov_b32 s61, 552960
  buffer_load_dwordx4 v[92:95], v238, s[36:39], s61 offen sc1
  s_waitcnt vmcnt(0)
  v_xor_b32 v8, s26, v65
  v_xor_b32 v9, s26, v67
  v_or_b32 v8, v8, v9
  v_xor_b32 v9, s26, v69
  v_or_b32 v8, v8, v9
  v_xor_b32 v9, s26, v71
  v_or_b32 v8, v8, v9
  v_xor_b32 v9, s26, v73
  v_or_b32 v8, v8, v9
  v_xor_b32 v9, s26, v75
  v_or_b32 v8, v8, v9
  v_xor_b32 v9, s26, v77
  v_or_b32 v8, v8, v9
  v_xor_b32 v9, s26, v79
  v_or_b32 v8, v8, v9
  v_xor_b32 v9, s26, v81
  v_or_b32 v8, v8, v9
  v_xor_b32 v9, s26, v83
  v_or_b32 v8, v8, v9
  v_xor_b32 v9, s26, v85
  v_or_b32 v8, v8, v9
  v_xor_b32 v9, s26, v87
  v_or_b32 v8, v8, v9
  v_xor_b32 v9, s26, v89
  v_or_b32 v8, v8, v9
  v_xor_b32 v9, s26, v91
  v_or_b32 v8, v8, v9
  v_xor_b32 v9, s26, v93
  v_or_b32 v8, v8, v9
  v_xor_b32 v9, s26, v95
  v_or_b32 v8, v8, v9
  v_cmp_ne_u32 vcc, 0, v8
  s_cbranch_vccz L_polld_s_24
  s_mov_b64 exec, vcc
  s_sub_u32 s66, s66, 1
  s_cbranch_scc1 L_pollto_s_25
  s_sleep 1
  s_branch L_poll_s_23
L_pollto_s_25:
  v_mov_b32 v8, 16
  v_mov_b32 v9, s2
  v_add_u32 v9, 0x1000, v9
  global_store_dword v8, v9, s[22:23]
L_polld_s_24:
  s_mov_b64 exec, -1
  v_add_f32 v64, v64, v80
  v_add_f32 v66, v66, v82
  v_add_f32 v68, v68, v84
  v_add_f32 v70, v70, v86
  v_add_f32 v72, v72, v88
  v_add_f32 v74, v74, v90
  v_add_f32 v76, v76, v92
  v_add_f32 v78, v78, v94
  v_add_f32 v64, v64, v72
  v_add_f32 v66, v66, v74
  v_add_f32 v68, v68, v76
  v_add_f32 v70, v70, v78
  v_add_f32 v16, v64, v68
  v_add_f32 v18, v66, v70
  s_nop 1
  v_add_f32_dpp v16, v16, v16 row_ror:4 row_mask:0xf bank_mask:0xf
  v_add_f32_dpp v18, v18, v18 row_ror:4 row_mask:0xf bank_mask:0xf
  s_nop 1
  v_add_f32_dpp v16, v16, v16 row_ror:8 row_mask:0xf bank_mask:0xf
  v_add_f32_dpp v18, v18, v18 row_ror:8 row_mask:0xf bank_mask:0xf
  s_nop 0
  v_mov_b32 v20, v16
  v_mov_b32 v21, v18
  s_nop 1
  v_permlane16_swap_b32 v16, v20
  v_permlane16_swap_b32 v18, v21
  s_nop 0
  v_add_f32 v16, v16, v20
  v_add_f32 v18, v18, v21
  v_cvt_pk_bf16_f32 v8, v16, v18
  v_lshlrev_b32 v10, 16, v8
  v_and_b32 v11, 0xffff0000, v8
  v_mul_f32 v10, v10, v224
  v_mul_f32 v11, v11, v225
  v_cvt_pk_bf16_f32 v8, v10, v11
  v_lshlrev_b32 v10, 16, v8
  v_and_b32 v11, 0xffff0000, v8
  v_lshlrev_b32 v12, 16, v226
  v_and_b32 v13, 0xffff0000, v226
  v_add_f32 v10, v10, v12
  v_add_f32 v11, v11, v13
  v_cvt_pk_bf16_f32 v8, v10, v11
  s_mov_b32 exec_lo, 0xf
  s_mov_b32 exec_hi, 0xf
  buffer_store_dword v8, v239, s[48:51], 0 offen
  s_mov_b64 exec, -1
  s_cmp_lg_u32 s2, 0
  s_cbranch_scc1 L_fin
  v_mov_b32 v8, s26
  v_mov_b32 v1, 0
  s_mov_b64 exec, 1
  buffer_store_dword v8, v1, s[36:39], 0 offen sc1
  s_mov_b64 exec, -1
L_fin:
L_end:
  s_endpgm
L_code_end:
.section .rodata,"a"
.p2align 6
.amdhsa_kernel recurrent_scan__gqa_block_cached__dense_activation_silu__decode_kernel
  .amdhsa_next_free_vgpr 240
  .amdhsa_next_free_sgpr 102
  .amdhsa_accum_offset 240
  .amdhsa_group_segment_fixed_size 0
  .amdhsa_kernarg_size 88
  .amdhsa_user_sgpr_count 2
  .amdhsa_user_sgpr_kernarg_segment_ptr 1
  .amdhsa_system_sgpr_workgroup_id_x 1
  .amdhsa_float_denorm_mode_32 3
  .amdhsa_float_denorm_mode_16_64 3
.end_amdhsa_kernel
```
